```python
import torch

def _softmax(x, axis=-1):
    return torch.softmax(x, dim=axis)
def _gelu(x):
    return torch.nn.functional.gelu(x, approximate="tanh")
def _silu(x):
    return torch.nn.functional.silu(x)
def _sigmoid(x):
    return torch.sigmoid(x)
def _layernorm(x, axis=-1, eps=1e-5):
    m = x.mean(dim=axis, keepdim=True)
    v = x.var(dim=axis, keepdim=True, unbiased=False)
    return (x - m) / torch.sqrt(v + eps)
def _scatter_add(tgt, idx, src, axis=0):
    return tgt.clone().index_add_(axis, idx, src)
def _segment_sum(src, seg, n):
    out = torch.zeros((n,) + src.shape[1:], dtype=src.dtype)
    return out.index_add_(0, seg, src)
def _pad(x, pw):
    flat = tuple(v for pair in reversed(pw) for v in pair)
    return torch.nn.functional.pad(x, flat)

kernel_name = 'gather_scatter__isomorphism_gin_2__graph'

def setup_inputs():

    _w = (lambda a: (lambda t: t.to(torch.bfloat16) if t.is_floating_point() else t)(torch.as_tensor(a)))
    N, deg, D = 10000, 16, 256
    E = N * deg
    H = 2 * D
    src = (lambda lo, hi, *s: torch.randint(lo, hi, s))(0, N, E).to(torch.int64)
    dst = (lambda lo, hi, *s: torch.randint(lo, hi, s))(0, N, E).to(torch.int64)
    return {
        "x": _w((lambda *s: torch.randn(*s, dtype=torch.bfloat16) * 0.05)(N, D)),
        "src": _w(src),
        "dst": _w(dst),
        "eps": _w((lambda *s: torch.randn(*s, dtype=torch.bfloat16) * 0.05)(1) * 0.1),
        "w1": _w((lambda *s: torch.randn(*s, dtype=torch.bfloat16) * 0.05)(D, H) * D ** -0.5),
        "b1": _w((lambda *s: torch.randn(*s, dtype=torch.bfloat16) * 0.4)(H) * 0.01),
        "w2": _w((lambda *s: torch.randn(*s, dtype=torch.bfloat16) * 0.05)(H, D) * H ** -0.5),
        "b2": _w((lambda *s: torch.randn(*s, dtype=torch.bfloat16) * 0.05)(D) * 0.01),
    }

def reference(x, src, dst, eps, w1, b1, w2, b2):
    N = x.shape[0]
    agg = _segment_sum(x[src], dst, N)
    h = (1.0 + eps) * x + agg
    h = torch.einsum('nd,dh->nh', h, w1) + b1
    h = torch.where(h > 0, h, 0.0 * h)
    h = torch.einsum('nh,hd->nd', h, w2) + b2
    return h
```

```asm
; @launch grid=(250,1,1) block=(512,1,1) lds=158848
.amdgcn_target "amdgcn-amd-amdhsa--gfx950"
.text
.globl gather_scatter__isomorphism_gin_2__graph_kernel
.p2align 8
.type gather_scatter__isomorphism_gin_2__graph_kernel,@function
gather_scatter__isomorphism_gin_2__graph_kernel:
    s_cmp_ge_u32 s2, 250
    s_cbranch_scc1 L_end
    s_load_dwordx16 s[8:23], s[0:1], 0
    s_load_dwordx4 s[24:27], s[0:1], 64
    s_load_dwordx2 s[28:29], s[0:1], 80
    v_and_b32 v1, 63, v0
    v_lshrrev_b32 v4, 6, v0
    v_lshrrev_b32 v2, 4, v1
    v_readfirstlane_b32 s60, v4
    v_and_b32 v3, 15, v0
    s_mul_i32 s96, s2, 40
    s_cmp_lg_u32 s60, 7
    s_cbranch_scc1 L_nocpf
    s_getpc_b64 s[70:71]
L_cpf:
    v_lshlrev_b32 v5, 7, v1
    global_load_dword v31, v5, s[70:71]
    v_add_u32 v5, 8192, v5
    v_min_u32 v5, L_end-L_cpf, v5
    s_mov_b32 exec_hi, 0
    global_load_dword v31, v5, s[70:71]
    s_mov_b64 exec, -1
L_nocpf:
    v_lshlrev_b32 v28, 4, v1
    v_lshlrev_b32 v120, 4, v0
    v_mov_b32 v32, 1032192
    v_mov_b32 v33, 1032192
    v_mov_b32 v34, 1032192
    v_mov_b32 v35, 1032192
    ds_write_b128 v120, v[32:35] offset:43136
    ds_write_b128 v120, v[32:35] offset:51328
    ds_write_b128 v120, v[32:35] offset:34944
    v_mov_b32 v16, 2130706432
    v_mov_b32 v17, 2130706432
    v_mov_b32 v18, 2130706432
    v_mov_b32 v19, 2130706432
    ds_write_b128 v120, v[16:19] offset:3584
    v_mov_b32 v5, 0
    v_lshlrev_b32 v6, 2, v0
    v_cmp_gt_u32 vcc, 256, v0
    s_and_saveexec_b64 s[68:69], vcc
    ds_write_b32 v6, v5 offset:59520
    v_cmp_gt_u32 vcc, 128, v0
    s_and_b64 exec, exec, vcc
    ds_write_b128 v120, v[16:19] offset:11776
    ds_write_b32 v6, v5 offset:0
    s_mov_b64 exec, s[68:69]
    s_lshr_b32 s84, s2, 4
    s_lshl_b32 s84, s84, 3
    s_and_b32 s63, s2, 7
    s_add_u32 s84, s84, s63
    s_lshl_b32 s87, s84, 1
    s_lshr_b32 s63, s60, 2
    s_add_u32 s87, s87, s63
    s_and_b32 s63, s60, 3
    s_cmp_eq_u32 s63, 3
    s_cselect_b32 s93, 1, 0
    s_cmp_lt_u32 s87, 128
    s_cselect_b32 s93, s93, 0
    s_bitcmp1_b32 s2, 3
    s_cselect_b32 s93, s93, 0
    s_cselect_b32 s84, 255, s84
    s_mul_i32 s63, s84, 5120
    s_mul_i32 s64, s60, 640
    s_add_u32 s63, s63, s64
    v_lshlrev_b32 v6, 2, v1
    s_lshr_b32 s61, s2, 4
    s_bfe_u32 s64, s2, 0x10003
    s_lshl_b32 s64, s64, 2
    s_add_u32 s61, s61, s64
    s_lshr_b32 s98, s2, 4
    s_add_u32 s98, s98, s2
    s_and_b32 s98, s98, 7
    s_and_b32 s64, s2, 0x88
    s_or_b32 s98, s98, s64
    s_mov_b32 s38, 640000
    s_mov_b32 s39, 0x00020000
    s_mov_b32 s42, 640000
    s_mov_b32 s43, 0x00020000
    s_waitcnt lgkmcnt(0)
    s_mov_b32 s40, s12
    s_and_b32 s41, s13, 0xffff
    s_mov_b32 s36, s10
    s_and_b32 s37, s11, 0xffff
    s_cmp_ge_u32 s84, 125
    s_cbranch_scc1 L_noedge
    buffer_load_dword v32, v6, s[40:43], s63 offen
    buffer_load_dword v33, v6, s[40:43], s63 offen offset:256
    buffer_load_dword v36, v6, s[36:39], s63 offen
    buffer_load_dword v37, v6, s[36:39], s63 offen offset:256
    s_mov_b32 exec_hi, 0
    buffer_load_dword v34, v6, s[40:43], s63 offen offset:512
    buffer_load_dword v38, v6, s[36:39], s63 offen offset:512
    s_mov_b64 exec, -1
L_noedge:
    s_load_dword s30, s[28:29], 0
    s_load_dword s86, s[14:15], 0
    s_mov_b32 s44, s16
    s_and_b32 s45, s17, 0xffff
    s_mov_b32 s46, 262144
    s_mov_b32 s47, 0x00020000
    s_mov_b32 s32, s8
    s_and_b32 s33, s9, 0xffff
    s_mov_b32 s34, 5120000
    s_mov_b32 s35, 0x00020000
    s_barrier
    s_and_b32 s63, s2, 0xf8
    s_add_u32 s63, s63, s60
    s_lshl_b32 s63, s63, 10
    v_lshlrev_b32 v5, 7, v1
    s_mov_b64 exec, 0xff
    buffer_load_dword v30, v5, s[44:47], s63 offen
    s_mov_b64 exec, -1
    s_mul_i32 s63, s60, 5
    s_add_u32 s63, s63, s96
    s_lshl_b32 s63, s63, 9
    buffer_load_dwordx4 v[96:99], v28, s[32:35], s63 offen
    buffer_load_dwordx4 v[100:103], v28, s[32:35], s63 offen offset:1024
    s_mov_b32 exec_hi, 0
    buffer_load_dwordx4 v[104:107], v28, s[32:35], s63 offen offset:2048
    s_mov_b64 exec, -1
    s_sub_u32 s65, s60, 1
    s_cmp_ge_u32 s65, 2
    s_cbranch_scc1 L_nbl
    s_cmp_eq_u32 s65, 0
    s_cselect_b32 s68, s18, s22
    s_cselect_b32 s69, s19, s23
    s_cselect_b32 exec_hi, -1, 0
    global_load_dwordx4 v[108:111], v28, s[68:69]
    s_mov_b64 exec, -1
L_nbl:
    s_mov_b32 s48, s20
    s_and_b32 s49, s21, 0xffff
    s_mov_b32 s50, 262144
    s_mov_b32 s51, 0x00020000
    s_cmp_eq_u32 s93, 0
    s_cbranch_scc1 L_nohelp0
    v_lshrrev_b32 v6, 5, v1
    v_bfe_u32 v7, v1, 4, 1
    v_lshl_add_u32 v5, v7, 4, v6
    s_and_b32 s64, s87, 7
    s_lshl_b32 s64, s64, 1
    s_and_b32 s63, s87, 8
    s_lshl_b32 s63, s63, 2
    s_add_u32 s64, s64, s63
    v_add_u32 v5, s64, v5
    v_lshrrev_b32 v6, 2, v5
    v_and_b32 v5, 3, v5
    v_lshlrev_b32 v6, 14, v6
    v_lshl_add_u32 v6, v5, 11, v6
    v_and_b32 v5, 15, v1
    v_lshl_add_u32 v6, v5, 2, v6
    s_lshr_b32 s63, s87, 4
    s_lshl_b32 s63, s63, 6
    s_add_u32 s64, s63, 8192
    buffer_load_dword v80, v6, s[48:51], s63 offen offset:0
    buffer_load_dword v81, v6, s[48:51], s63 offen offset:512
    buffer_load_dword v82, v6, s[48:51], s63 offen offset:1024
    buffer_load_dword v83, v6, s[48:51], s63 offen offset:1536
    buffer_load_dword v84, v6, s[48:51], s64 offen offset:0
    buffer_load_dword v85, v6, s[48:51], s64 offen offset:512
    buffer_load_dword v86, v6, s[48:51], s64 offen offset:1024
    buffer_load_dword v87, v6, s[48:51], s64 offen offset:1536
L_nohelp0:
    s_mov_b32 s56, s28
    s_and_b32 s57, s29, 0xffff
    s_mov_b32 s58, 147849216
    s_mov_b32 s59, 0x00020000
    s_mov_b32 s52, s24
    s_and_b32 s53, s25, 0xffff
    s_mov_b32 s54, 5120000
    s_mov_b32 s55, 0x00020000
    s_mov_b32 s67, 65536
    v_lshrrev_b32 v5, 1, v2
    v_and_b32 v6, 1, v2
    v_lshl_add_u32 v121, v6, 4, v5
    s_lshl_b32 s63, s60, 7
    s_mul_i32 s62, s60, 12288
    s_add_u32 s62, s62, 60544
    v_lshrrev_b32 v5, 3, v1
    v_and_b32 v7, 2, v5
    v_and_b32 v27, 7, v1
    v_xor_b32 v27, v27, v7
    v_lshlrev_b32 v122, 10, v5
    v_add_u32 v122, s63, v122
    v_xor_b32 v7, 4, v27
    v_lshl_add_u32 v123, v7, 4, v122
    v_add_u32 v123, 0x20000, v123
    v_lshl_add_u32 v122, v27, 4, v122
    v_and_b32 v20, 31, v1
    v_lshlrev_b32 v20, 4, v20
    v_lshrrev_b32 v5, 1, v2
    v_lshrrev_b32 v21, 5, v1
    v_lshlrev_b32 v21, 4, v21
    s_lshl_b32 s63, s60, 10
    v_add_u32 v21, s63, v21
    s_lshl_b32 s64, s61, 1
    v_subrev_u32 v22, s64, v3
    v_and_b32 v22, 15, v22
    v_lshl_add_u32 v22, v5, 4, v22
    v_lshlrev_b32 v22, 4, v22
    v_lshl_add_u32 v22, v6, 3, v22
    v_mul_u32_u24 v23, 528, v3
    v_lshl_add_u32 v23, v121, 4, v23
    v_mul_u32_u24 v7, 1040, v3
    v_add_u32 v7, 43136, v7
    v_lshl_add_u32 v25, v121, 4, v7
    s_lshl_b32 s63, s60, 7
    s_and_b32 s63, s63, 0x300
    v_add_u32 v24, s63, v7
    s_lshl_b32 s63, s60, 8
    v_lshlrev_b32 v29, 4, v2
    v_add_u32 v29, s63, v29
    v_lshrrev_b32 v5, 2, v3
    v_and_b32 v7, 2, v5
    v_lshl_add_u32 v7, v6, 2, v7
    v_lshlrev_b32 v27, 10, v2
    v_lshl_add_u32 v27, v5, 7, v27
    v_and_b32 v5, 3, v3
    v_lshl_add_u32 v27, v5, 3, v27
    v_add_u32 v27, s62, v27
    v_xor_b32 v5, 0, v7
    v_lshl_add_u32 v124, v5, 4, v27
    v_xor_b32 v5, 2, v7
    v_lshl_add_u32 v125, v5, 4, v27
    v_xor_b32 v5, 4, v7
    v_lshl_add_u32 v126, v5, 4, v27
    v_xor_b32 v5, 6, v7
    v_lshl_add_u32 v127, v5, 4, v27
    v_mov_b32 v7, 0x3f80
    v_and_b32 v4, 1, v3
    v_lshlrev_b32 v4, 4, v4
    v_lshlrev_b32 v7, v4, v7
    v_lshlrev_b32 v5, 2, v6
    v_lshrrev_b32 v4, 1, v3
    v_sub_u32 v4, v4, v5
    v_cmp_eq_u32 vcc, 0, v4
    v_mov_b32 v12, 0
    s_nop 0
    v_cndmask_b32 v8, 0, v7, vcc
    v_cmp_eq_u32 vcc, 1, v4
    v_mov_b32 v13, 0
    s_nop 0
    v_cndmask_b32 v9, 0, v7, vcc
    v_cmp_eq_u32 vcc, 2, v4
    v_mov_b32 v14, 0
    s_nop 0
    v_cndmask_b32 v10, 0, v7, vcc
    v_cmp_eq_u32 vcc, 3, v4
    v_mov_b32 v15, 0
    s_nop 0
    v_cndmask_b32 v11, 0, v7, vcc
    v_cmp_gt_u32 vcc, 500, v0
    s_mov_b64 s[90:91], vcc
    s_lshl_b32 s100, s2, 13
    s_add_u32 s100, s100, 1048576
    s_cmp_ge_u32 s84, 125
    s_cbranch_scc1 L_stream
    s_lshl_b32 s63, s84, 6
    s_add_u32 s63, s63, 1048576
    v_lshrrev_b32 v6, 2, v0
    v_lshlrev_b32 v7, 2, v6
    v_and_b32 v5, 3, v0
    v_lshlrev_b32 v5, 4, v5
    v_lshl_add_u32 v6, v6, 13, v5
    v_mov_b32 v27, 1
    s_setprio 3
    s_sub_u32 s65, s60, 1
    s_cmp_lt_u32 s65, 2
    s_cbranch_scc1 L_ew1
    s_waitcnt vmcnt(4)
L_ew1:
    s_waitcnt vmcnt(5)
    v_mul_u32_u24 v40, 0xcccd, v32
    v_lshrrev_b32 v40, 21, v40
    v_lshlrev_b32 v5, 2, v40
    ds_add_rtn_u32 v44, v5, v27 offset:59520
    v_mul_u32_u24 v41, 0xcccd, v33
    v_lshrrev_b32 v41, 21, v41
    v_lshlrev_b32 v5, 2, v41
    ds_add_rtn_u32 v45, v5, v27 offset:59520
    s_mov_b32 exec_hi, 0
    v_mul_u32_u24 v42, 0xcccd, v34
    v_lshrrev_b32 v42, 21, v42
    v_lshlrev_b32 v5, 2, v42
    ds_add_rtn_u32 v46, v5, v27 offset:59520
    s_mov_b64 exec, -1
    v_mul_u32_u24 v5, 40, v40
    v_sub_u32 v5, v32, v5
    v_lshl_or_b32 v36, v5, 14, v36
    v_lshlrev_b32 v40, 6, v40
    v_mul_u32_u24 v5, 40, v41
    v_sub_u32 v5, v33, v5
    v_lshl_or_b32 v37, v5, 14, v37
    v_lshlrev_b32 v41, 6, v41
    v_mul_u32_u24 v5, 40, v42
    v_sub_u32 v5, v34, v5
    v_lshl_or_b32 v38, v5, 14, v38
    v_lshlrev_b32 v42, 6, v42
    s_waitcnt lgkmcnt(0)
    v_lshl_add_u32 v5, v44, 2, v40
    v_cmp_gt_u32 vcc, 16, v44
    v_min_u32 v4, 22, v44
    v_lshrrev_b32 v40, 1, v40
    v_lshl_add_u32 v4, v4, 2, v40
    v_add_u32 v5, 8256, v5
    v_cndmask_b32 v5, v4, v5, vcc
    ds_write_b32 v5, v36 offset:34880
    v_lshl_add_u32 v5, v45, 2, v41
    v_cmp_gt_u32 vcc, 16, v45
    v_min_u32 v4, 22, v45
    v_lshrrev_b32 v41, 1, v41
    v_lshl_add_u32 v4, v4, 2, v41
    v_add_u32 v5, 8256, v5
    v_cndmask_b32 v5, v4, v5, vcc
    ds_write_b32 v5, v37 offset:34880
    s_mov_b32 exec_hi, 0
    v_lshl_add_u32 v5, v46, 2, v42
    v_cmp_gt_u32 vcc, 16, v46
    v_min_u32 v4, 22, v46
    v_lshrrev_b32 v42, 1, v42
    v_lshl_add_u32 v4, v4, 2, v42
    v_add_u32 v5, 8256, v5
    v_cndmask_b32 v5, v4, v5, vcc
    ds_write_b32 v5, v38 offset:34880
    s_mov_b64 exec, -1
    s_add_u32 s30, s30, 1
    s_add_u32 s4, s30, 0
    s_lshl_b32 s4, s4, 20
    s_add_u32 s5, s30, 1365
    s_lshl_b32 s5, s5, 20
    s_add_u32 s6, s30, 2730
    s_lshl_b32 s6, s6, 20
    s_add_u32 s7, s30, 963
    s_lshl_b32 s7, s7, 20
    v_mov_b32 v5, 1015808
    s_waitcnt lgkmcnt(0)
    s_barrier
    ds_read_b128 v[32:35], v120 offset:43136
    ds_read_b128 v[36:39], v120 offset:51328
    ds_read_b32 v112, v7 offset:59520
    ds_read_b32 v113, v7 offset:60032
    s_waitcnt lgkmcnt(0)
    v_max_u32 v4, v112, v113
    v_cmp_lt_u32 vcc, 16, v4
    s_cbranch_vccnz L_cont_p
L_cont_pd:
    v_or_b32 v32, s4, v32
    v_or_b32 v33, s5, v33
    v_or_b32 v34, s6, v34
    v_or_b32 v35, s7, v35
    buffer_store_dwordx4 v[32:35], v6, s[56:59], s63 offen sc1
    s_add_u32 s63, s63, 1048576
    v_or_b32 v36, s4, v36
    v_or_b32 v37, s5, v37
    v_or_b32 v38, s6, v38
    v_or_b32 v39, s7, v39
    v_cmp_gt_u32 vcc, 488, v0
    s_mov_b64 exec, vcc
    buffer_store_dwordx4 v[36:39], v6, s[56:59], s63 offen sc1
    s_add_u32 s63, s63, 1048576
    s_nop 1
L_nostore:
    s_mov_b64 exec, -1
    s_setprio 0
L_stream:
    s_setprio 2
    s_add_u32 s31, s61, 0
    s_and_b32 s31, s31, 7
    s_lshl_b32 s31, s31, 14
    s_add_u32 s66, s31, 8192
    s_add_u32 m0, s62, 0
    s_nop 0
    buffer_load_dwordx4 v122, s[44:47], s31 offen lds
    s_add_u32 m0, s62, 1024
    s_nop 0
    buffer_load_dwordx4 v123, s[44:47], s31 offen lds
    s_add_u32 m0, s62, 2048
    s_nop 0
    buffer_load_dwordx4 v122, s[44:47], s66 offen lds
    s_add_u32 m0, s62, 3072
    s_nop 0
    buffer_load_dwordx4 v123, s[44:47], s66 offen lds
    s_add_u32 s31, s61, 1
    s_and_b32 s31, s31, 7
    s_lshl_b32 s31, s31, 14
    s_add_u32 s66, s31, 8192
    s_add_u32 m0, s62, 4096
    s_nop 0
    buffer_load_dwordx4 v122, s[44:47], s31 offen lds
    s_add_u32 m0, s62, 5120
    s_nop 0
    buffer_load_dwordx4 v123, s[44:47], s31 offen lds
    s_add_u32 m0, s62, 6144
    s_nop 0
    buffer_load_dwordx4 v122, s[44:47], s66 offen lds
    s_add_u32 m0, s62, 7168
    s_nop 0
    buffer_load_dwordx4 v123, s[44:47], s66 offen lds
    s_add_u32 s31, s61, 2
    s_and_b32 s31, s31, 7
    s_lshl_b32 s31, s31, 14
    s_add_u32 s66, s31, 8192
    s_add_u32 m0, s62, 8192
    s_nop 0
    buffer_load_dwordx4 v122, s[44:47], s31 offen lds
    s_add_u32 m0, s62, 9216
    s_nop 0
    buffer_load_dwordx4 v123, s[44:47], s31 offen lds
    s_add_u32 m0, s62, 10240
    s_nop 0
    buffer_load_dwordx4 v122, s[44:47], s66 offen lds
    s_add_u32 m0, s62, 11264
    s_nop 0
    buffer_load_dwordx4 v123, s[44:47], s66 offen lds
    v_mov_b32 v40, 1032192
    v_mov_b32 v41, 1032192
    v_mov_b32 v42, 1032192
    v_mov_b32 v43, 1032192
    s_waitcnt vmcnt(8)
    ds_read_b64_tr_b16 v[128:129], v124 offset:0
    ds_read_b64_tr_b16 v[130:131], v124 offset:512
    ds_read_b64_tr_b16 v[132:133], v125 offset:0
    ds_read_b64_tr_b16 v[134:135], v125 offset:512
    ds_read_b64_tr_b16 v[136:137], v126 offset:0
    ds_read_b64_tr_b16 v[138:139], v126 offset:512
    ds_read_b64_tr_b16 v[140:141], v127 offset:0
    ds_read_b64_tr_b16 v[142:143], v127 offset:512
    v_lshrrev_b32 v5, 5, v1
    s_mul_i32 s63, s60, 5
    v_add_u32 v5, s63, v5
    v_mul_u32_u24 v5, 528, v5
    s_lshl_b32 s63, s61, 5
    v_subrev_u32 v6, s63, v20
    v_and_b32 v6, 0xf0, v6
    v_and_b32 v7, 0x100, v20
    v_add3_u32 v5, v5, v6, v7
    ds_write_b128 v5, v[96:99] offset:13824
    ds_write_b128 v5, v[100:103] offset:14880
    s_mov_b32 exec_hi, 0
    ds_write_b128 v5, v[104:107] offset:15936
    s_mov_b64 exec, -1
    s_sub_u32 s65, s60, 1
    s_cmp_ge_u32 s65, 2
    s_cbranch_scc1 L_nbias
    v_lshlrev_b32 v5, 5, v1
    s_cmp_eq_u32 s65, 1
    s_cbranch_scc1 L_bias2
    v_lshlrev_b32 v64, 16, v108
    v_and_b32 v65, 0xffff0000, v108
    v_lshlrev_b32 v66, 16, v109
    v_and_b32 v67, 0xffff0000, v109
    v_lshlrev_b32 v68, 16, v110
    v_and_b32 v69, 0xffff0000, v110
    v_lshlrev_b32 v70, 16, v111
    v_and_b32 v71, 0xffff0000, v111
    ds_write_b128 v5, v[64:67] offset:512
    ds_write_b128 v5, v[68:71] offset:528
    s_branch L_nbias
L_bias2:
    v_lshlrev_b32 v64, 16, v108
    v_and_b32 v68, 0xffff0000, v108
    v_lshlrev_b32 v65, 16, v109
    v_and_b32 v69, 0xffff0000, v109
    v_lshlrev_b32 v66, 16, v110
    v_and_b32 v70, 0xffff0000, v110
    v_lshlrev_b32 v67, 16, v111
    v_and_b32 v71, 0xffff0000, v111
    s_mov_b32 exec_hi, 0
    ds_write_b128 v5, v[64:67] offset:2560
    ds_write_b128 v5, v[68:71] offset:2576
    s_mov_b64 exec, -1
L_nbias:
    s_waitcnt lgkmcnt(0)
    s_add_u32 s31, s61, 3
    s_and_b32 s31, s31, 7
    s_lshl_b32 s31, s31, 14
    s_add_u32 s66, s31, 8192
    s_add_u32 m0, s62, 0
    s_nop 0
    buffer_load_dwordx4 v122, s[44:47], s31 offen lds
    s_add_u32 m0, s62, 1024
    s_nop 0
    buffer_load_dwordx4 v123, s[44:47], s31 offen lds
    s_add_u32 m0, s62, 2048
    s_nop 0
    buffer_load_dwordx4 v122, s[44:47], s66 offen lds
    s_add_u32 m0, s62, 3072
    s_nop 0
    buffer_load_dwordx4 v123, s[44:47], s66 offen lds
    s_mov_b32 s63, s87
    s_cmp_eq_u32 s93, 0
    s_cbranch_scc1 L_nohelp
    s_lshl_b32 s63, s87, 11
    s_add_u32 s63, s63, s67
    s_mov_b32 s85, 0x05040100
    s_mov_b32 s99, 0x07060302
    s_waitcnt vmcnt(63)
    v_perm_b32 v88, v81, v80, s85
    v_perm_b32 v92, v81, v80, s99
    v_perm_b32 v89, v83, v82, s85
    v_perm_b32 v93, v83, v82, s99
    v_perm_b32 v90, v85, v84, s85
    v_perm_b32 v94, v85, v84, s99
    v_perm_b32 v91, v87, v86, s85
    v_perm_b32 v95, v87, v86, s99
    buffer_store_dwordx4 v[88:91], v28, s[56:59], s63 offen sc1
    buffer_store_dwordx4 v[92:95], v28, s[56:59], s63 offen offset:1024 sc1
    s_nop 1
L_nohelp:
    s_cmp_lg_u32 s98, 0x8f
    s_cbranch_scc1 L_nodump
    s_and_b32 s63, s61, 7
    s_lshl_b32 s63, s63, 12
    s_lshl_b32 s64, s60, 15
    s_add_u32 s63, s63, s64
    s_add_u32 s63, s63, 327680
    buffer_store_dwordx4 v[128:131], v28, s[56:59], s63 offen offset:0 sc1
    buffer_store_dwordx4 v[132:135], v28, s[56:59], s63 offen offset:1024 sc1
    buffer_store_dwordx4 v[136:139], v28, s[56:59], s63 offen offset:2048 sc1
    buffer_store_dwordx4 v[140:143], v28, s[56:59], s63 offen offset:3072 sc1
L_nodump:
    s_waitcnt vmcnt(8)
    ds_read_b64_tr_b16 v[144:145], v124 offset:4096
    ds_read_b64_tr_b16 v[146:147], v124 offset:4608
    ds_read_b64_tr_b16 v[148:149], v125 offset:4096
    ds_read_b64_tr_b16 v[150:151], v125 offset:4608
    ds_read_b64_tr_b16 v[152:153], v126 offset:4096
    ds_read_b64_tr_b16 v[154:155], v126 offset:4608
    ds_read_b64_tr_b16 v[156:157], v127 offset:4096
    ds_read_b64_tr_b16 v[158:159], v127 offset:4608
    s_setprio 1
    s_waitcnt lgkmcnt(0)
    s_add_u32 s31, s61, 4
    s_and_b32 s31, s31, 7
    s_lshl_b32 s31, s31, 14
    s_add_u32 s66, s31, 8192
    s_add_u32 m0, s62, 4096
    s_nop 0
    buffer_load_dwordx4 v122, s[44:47], s31 offen lds
    s_add_u32 m0, s62, 5120
    s_nop 0
    buffer_load_dwordx4 v123, s[44:47], s31 offen lds
    s_add_u32 m0, s62, 6144
    s_nop 0
    buffer_load_dwordx4 v122, s[44:47], s66 offen lds
    s_add_u32 m0, s62, 7168
    s_nop 0
    buffer_load_dwordx4 v123, s[44:47], s66 offen lds
    s_cmp_lt_u32 s84, 125
    s_cbranch_scc1 L_npf_1
    s_cmp_eq_u32 s98, 0x8f
    s_cbranch_scc1 L_npf_1
    s_and_b32 s63, s2, 7
    s_mul_i32 s63, s63, 5000
    s_lshl_b32 s64, s60, 4
    s_lshr_b32 s65, s2, 4
    s_add_u32 s64, s64, s65
    s_mul_i32 s64, s64, 64
    s_add_u32 s63, s63, s64
    v_add_u32 v5, s63, v1
    v_subrev_u32 v6, 40000, v5
    v_min_u32 v5, v6, v5
    v_lshlrev_b32 v5, 7, v5
    v_cmp_gt_u32 vcc, 64, v1
    s_mov_b64 exec, vcc
    buffer_load_dword v30, v5, s[32:35], 0 offen
    s_add_u32 s63, s63, 64
L_npf_1:
    s_mov_b64 exec, s[90:91]
    buffer_load_dwordx4 v[40:43], v120, s[56:59], s100 offen sc1
    s_mov_b64 exec, -1
    s_lshl_b32 s86, s86, 16
    v_add_f32 v4, s86, 1.0
    v_cvt_pk_bf16_f32 v4, v4, v4
    v_lshlrev_b32 v4, 16, v4
    v_add_u32 v7, s96, v3
    v_readfirstlane_b32 s86, v4
    v_lshlrev_b32 v7, 9, v7
    v_lshl_add_u32 v7, v2, 4, v7
    s_lshl_b32 s63, s60, 6
    v_add_u32 v0, s63, v7
    s_lshl_b32 s63, s60, 3
    s_lshl_b32 s64, s61, 1
    s_sub_u32 s63, s63, s64
    v_add_u32 v7, s63, v2
    v_add_u32 v5, 4, v7
    v_and_b32 v7, 15, v7
    v_and_b32 v5, 15, v5
    v_lshl_add_u32 v2, v5, 4, v24
    v_lshl_add_u32 v24, v7, 4, v24
    s_mov_b32 s81, 0
    s_lshl_b32 s63, s60, 2
    s_lshl_b32 s64, s60, 1
    s_add_u32 s64, s64, 32
    s_add_u32 s65, s63, 2
    s_cmp_lt_u32 s60, 4
    s_cselect_b32 s82, 6, 4
    s_cselect_b32 s22, s64, s63
    s_cselect_b32 s24, s63, s65
    s_cselect_b32 s26, s65, 46
    s_cselect_b32 s101, 0, 4
    s_add_u32 s23, s22, 1
    s_add_u32 s25, s24, 1
    s_add_u32 s27, s26, 1
    s_mov_b64 s[20:21], 0
    s_lshl_b64 s[20:21], s[20:21], 8
    s_or_b32 s20, s20, s27
    s_lshl_b64 s[20:21], s[20:21], 8
    s_or_b32 s20, s20, s26
    s_lshl_b64 s[20:21], s[20:21], 8
    s_or_b32 s20, s20, s25
    s_lshl_b64 s[20:21], s[20:21], 8
    s_or_b32 s20, s20, s24
    s_lshl_b64 s[20:21], s[20:21], 8
    s_or_b32 s20, s20, s23
    s_lshl_b64 s[20:21], s[20:21], 8
    s_or_b32 s20, s20, s22
    s_mov_b64 s[78:79], 0
    s_lshl_b32 s63, s60, 15
    s_add_u32 s67, s67, s63
    v_lshrrev_b32 v16, 5, v1
    v_lshlrev_b32 v16, 4, v16
    s_lshl_b32 s63, s22, 8
    v_add_u32 v16, s63, v16
    s_mul_i32 s63, s22, 528
    v_add_u32 v17, s63, v22
    v_lshlrev_b32 v18, 2, v1
    v_mov_b32 v19, 0
    s_waitcnt vmcnt(9)
    ds_read_b64_tr_b16 v[160:161], v124 offset:8192
    ds_read_b64_tr_b16 v[162:163], v124 offset:8704
    ds_read_b64_tr_b16 v[164:165], v125 offset:8192
    ds_read_b64_tr_b16 v[166:167], v125 offset:8704
    ds_read_b64_tr_b16 v[168:169], v126 offset:8192
    ds_read_b64_tr_b16 v[170:171], v126 offset:8704
    ds_read_b64_tr_b16 v[172:173], v127 offset:8192
    ds_read_b64_tr_b16 v[174:175], v127 offset:8704
    s_waitcnt lgkmcnt(0)
    s_add_u32 s31, s61, 5
    s_and_b32 s31, s31, 7
    s_lshl_b32 s31, s31, 14
    s_add_u32 s66, s31, 8192
    s_add_u32 m0, s62, 8192
    s_nop 0
    buffer_load_dwordx4 v122, s[44:47], s31 offen lds
    s_add_u32 m0, s62, 9216
    s_nop 0
    buffer_load_dwordx4 v123, s[44:47], s31 offen lds
    s_add_u32 m0, s62, 10240
    s_nop 0
    buffer_load_dwordx4 v122, s[44:47], s66 offen lds
    s_add_u32 m0, s62, 11264
    s_nop 0
    buffer_load_dwordx4 v123, s[44:47], s66 offen lds
    s_cmp_lt_u32 s84, 125
    s_cbranch_scc1 L_hastag
    s_add_u32 s30, s30, 1
    s_add_u32 s4, s30, 0
    s_lshl_b32 s4, s4, 20
    s_add_u32 s5, s30, 1365
    s_lshl_b32 s5, s5, 20
    s_add_u32 s6, s30, 2730
    s_lshl_b32 s6, s6, 20
    s_add_u32 s7, s30, 963
    s_lshl_b32 s7, s7, 20
L_hastag:
    s_mov_b32 s83, 0
    s_mov_b32 s65, 0x100000
    v_mov_b32 v27, 1
    s_mov_b64 s[76:77], 0
    s_mov_b32 s92, 0
    s_mov_b32 s10, 0
    s_mov_b64 exec, s[90:91]
    s_waitcnt vmcnt(4)
L_pchk:
    v_xor_b32 v40, s4, v40
    v_xor_b32 v41, s5, v41
    v_xor_b32 v42, s6, v42
    v_xor_b32 v43, s7, v43
    v_or3_b32 v5, v40, v41, v42
    v_or_b32 v5, v5, v43
    v_cmp_le_u32 vcc, s65, v5
    s_and_b64 exec, exec, vcc
    s_cbranch_execnz L_pmiss
L_polled:
    s_mov_b64 exec, -1
    v_cmp_eq_u32 vcc, 1015808, v40
    s_cbranch_vccnz L_setovf
L_noovf:
    v_cmp_eq_u32 vcc, 999424, v43
    s_mov_b64 s[8:9], vcc
L_ins:
    v_bfe_u32 v44, v40, 14, 6
    v_cmp_gt_u32 s[68:69], 40, v44
    v_lshlrev_b32 v52, 2, v44
    v_bfe_u32 v45, v41, 14, 6
    v_cmp_gt_u32 s[70:71], 40, v45
    v_lshlrev_b32 v53, 2, v45
    v_bfe_u32 v46, v42, 14, 6
    v_cmp_gt_u32 s[72:73], 40, v46
    v_lshlrev_b32 v54, 2, v46
    v_bfe_u32 v47, v43, 14, 6
    v_cmp_gt_u32 s[74:75], 40, v47
    v_lshlrev_b32 v55, 2, v47
    s_mov_b64 exec, s[68:69]
    ds_add_rtn_u32 v48, v52, v27 offset:0
    s_mov_b64 exec, s[70:71]
    ds_add_rtn_u32 v49, v53, v27 offset:0
    s_mov_b64 exec, s[72:73]
    ds_add_rtn_u32 v50, v54, v27 offset:0
    s_mov_b64 exec, s[74:75]
    ds_add_rtn_u32 v51, v55, v27 offset:0
    s_mov_b64 exec, -1
    v_and_b32 v40, 0x3fff, v40
    v_lshlrev_b32 v40, 9, v40
    v_lshlrev_b32 v52, 8, v44
    v_and_b32 v41, 0x3fff, v41
    v_lshlrev_b32 v41, 9, v41
    v_lshlrev_b32 v53, 8, v45
    v_and_b32 v42, 0x3fff, v42
    v_lshlrev_b32 v42, 9, v42
    v_lshlrev_b32 v54, 8, v46
    v_and_b32 v43, 0x3fff, v43
    v_lshlrev_b32 v43, 9, v43
    v_lshlrev_b32 v55, 8, v47
    s_waitcnt lgkmcnt(0)
    v_min_u32 v48, 63, v48
    v_lshl_add_u32 v52, v48, 2, v52
    v_min_u32 v49, 63, v49
    v_lshl_add_u32 v53, v49, 2, v53
    v_min_u32 v50, 63, v50
    v_lshl_add_u32 v54, v50, 2, v54
    v_min_u32 v51, 63, v51
    v_lshl_add_u32 v55, v51, 2, v55
    s_mov_b64 exec, s[68:69]
    ds_write_b32 v52, v40 offset:3584
    s_mov_b64 exec, s[70:71]
    ds_write_b32 v53, v41 offset:3584
    s_mov_b64 exec, s[72:73]
    ds_write_b32 v54, v42 offset:3584
    s_mov_b64 exec, s[74:75]
    ds_write_b32 v55, v43 offset:3584
    s_mov_b64 exec, -1
    s_or_b64 s[68:69], s[76:77], s[8:9]
    s_cbranch_scc1 L_more
    s_cmp_lg_u32 s98, 0x8f
    s_cbranch_scc1 L_nodf
    s_and_b32 s63, s61, 7
    s_lshl_b32 s63, s63, 3
    s_add_u32 s63, s63, s60
    s_add_u32 s63, s63, 128
    s_branch L_doflag
L_nodf:
    s_mov_b32 s63, s87
    s_cmp_eq_u32 s93, 0
    s_cbranch_scc1 L_noflag
L_doflag:
    s_mul_i32 s64, s30, 2654435761
    v_mov_b32 v6, s64
    s_lshl_b32 s63, s63, 2
    s_add_u32 s63, s63, 4096
    v_mov_b32 v5, 0
    s_mov_b64 exec, 1
    buffer_store_dword v6, v5, s[56:59], s63 offen sc1
    s_mov_b64 exec, -1
L_noflag:
    s_mov_b32 s100, 4096
    s_cmp_lt_u32 s60, 4
    s_setprio 1
    s_cbranch_scc0 L_prD
    s_setprio 2
L_prD:
    v_cmp_gt_u32 s[90:91], 40, v1
    s_waitcnt lgkmcnt(0)
    s_barrier
L_gsetup:
    ds_read_b128 v[96:99], v16 offset:3584
    ds_read_b32 v5, v18 offset:0
    ds_read_b32 v7, v19 offset:256
    ds_read_b64 v[30:31], v17 offset:13824
    s_add_u32 s68, s61, 0
    s_and_b32 s68, s68, 7
    s_lshl_b32 s68, s68, 11
    s_add_u32 s69, s61, 1
    s_and_b32 s69, s69, 7
    s_lshl_b32 s69, s69, 11
    s_add_u32 s70, s61, 2
    s_and_b32 s70, s70, 7
    s_lshl_b32 s70, s70, 11
    s_add_u32 s71, s61, 3
    s_and_b32 s71, s71, 7
    s_lshl_b32 s71, s71, 11
    s_add_u32 s72, s61, 4
    s_and_b32 s72, s72, 7
    s_lshl_b32 s72, s72, 11
    s_add_u32 s73, s61, 5
    s_and_b32 s73, s73, 7
    s_lshl_b32 s73, s73, 11
    s_add_u32 s74, s61, 6
    s_and_b32 s74, s74, 7
    s_lshl_b32 s74, s74, 11
    s_add_u32 s75, s61, 7
    s_and_b32 s75, s75, 7
    s_lshl_b32 s75, s75, 11
    s_waitcnt lgkmcnt(3)
    v_add_u32 v96, v96, v20
    v_add_u32 v97, v97, v20
    v_add_u32 v98, v98, v20
    v_add_u32 v99, v99, v20
    buffer_load_dwordx4 v[32:35], v96, s[32:35], 0 offen
    buffer_load_dwordx4 v[36:39], v97, s[32:35], 0 offen
    buffer_load_dwordx4 v[40:43], v98, s[32:35], 0 offen
    buffer_load_dwordx4 v[44:47], v99, s[32:35], 0 offen
    s_waitcnt lgkmcnt(0)
    v_cmp_lt_u32 vcc, 64, v5
    v_add_u32 v5, 1, v5
    v_lshrrev_b32 v5, 1, v5
    v_max_u32 v5, 1, v5
    v_cndmask_b32 v5, 0, v5, s[90:91]
    v_readfirstlane_b32 s3, v7
    v_readlane_b32 s8, v5, s22
    v_readlane_b32 s9, v5, s23
    v_readlane_b32 s10, v5, s24
    v_readlane_b32 s11, v5, s25
    v_readlane_b32 s12, v5, s26
    v_readlane_b32 s13, v5, s27
    s_cmp_lg_u64 vcc, 0
    s_cbranch_scc1 L_slow
    s_cmp_lg_u32 s3, 0
    s_cbranch_scc1 L_slow
    s_max_u32 s8, s8, 4
    s_add_u32 s9, s9, s8
    s_add_u32 s10, s10, s9
    s_add_u32 s11, s11, s10
    s_add_u32 s12, s12, s11
    s_add_u32 s13, s13, s12
    s_cmp_gt_u32 s13, 64
    s_cbranch_scc1 L_big
    v_mov_b32 v4, v1
    s_lshl_b32 s14, s22, 8
    s_lshl_b32 s15, s23, 5
    s_sub_u32 s15, s15, s8
    s_lshl_b32 s15, s15, 3
    s_lshl_b32 s16, s24, 5
    s_sub_u32 s16, s16, s9
    s_lshl_b32 s16, s16, 3
    s_lshl_b32 s17, s25, 5
    s_sub_u32 s17, s17, s10
    s_lshl_b32 s17, s17, 3
    s_lshl_b32 s18, s26, 5
    s_sub_u32 s18, s18, s11
    s_lshl_b32 s18, s18, 3
    s_lshl_b32 s19, s27, 5
    s_sub_u32 s19, s19, s12
    s_lshl_b32 s19, s19, 3
    v_mov_b32 v6, s14
    v_cmp_le_u32 vcc, s8, v4
    v_mov_b32 v7, s15
    s_nop 0
    v_cndmask_b32 v6, v6, v7, vcc
    v_cmp_le_u32 vcc, s9, v4
    v_mov_b32 v7, s16
    s_nop 0
    v_cndmask_b32 v6, v6, v7, vcc
    v_cmp_le_u32 vcc, s10, v4
    v_mov_b32 v7, s17
    s_nop 0
    v_cndmask_b32 v6, v6, v7, vcc
    v_cmp_le_u32 vcc, s11, v4
    v_mov_b32 v7, s18
    s_nop 0
    v_cndmask_b32 v6, v6, v7, vcc
    v_cmp_le_u32 vcc, s12, v4
    v_mov_b32 v7, s19
    s_nop 0
    v_cndmask_b32 v6, v6, v7, vcc
    v_lshl_add_u32 v6, v4, 3, v6
    v_mov_b32 v16, 2130706432
    v_mov_b32 v17, 2130706432
    v_cmp_gt_u32 vcc, s13, v4
    s_mov_b64 exec, vcc
    ds_read_b64 v[16:17], v6 offset:3584
    s_mov_b64 exec, -1
    v_lshrrev_b32 v7, 2, v4
    v_lshlrev_b32 v7, 5, v7
    v_and_b32 v5, 3, v4
    v_lshl_add_u32 v7, v5, 2, v7
    s_lshl_b32 s31, s60, 10
    v_add_u32 v7, s31, v7
    v_add_u32 v7, 34944, v7
    s_sub_u32 s31, s8, 1
    s_bitset1_b64 s[76:77], s31
    s_sub_u32 s31, s9, 1
    s_bitset1_b64 s[76:77], s31
    s_sub_u32 s31, s10, 1
    s_bitset1_b64 s[76:77], s31
    s_sub_u32 s31, s11, 1
    s_bitset1_b64 s[76:77], s31
    s_sub_u32 s31, s12, 1
    s_bitset1_b64 s[76:77], s31
    s_sub_u32 s31, s13, 1
    s_bitset1_b64 s[76:77], s31
    s_waitcnt lgkmcnt(0)
    ds_write2_b32 v7, v16, v17 offset0:0 offset1:4
L_listdone:
    s_add_u32 s29, s13, 3
    s_lshr_b32 s29, s29, 2
    s_max_u32 s80, s29, 4
L_prol:
    ds_read_b128 v[100:103], v21 offset:34976
    ds_read_b128 v[104:107], v21 offset:35008
    ds_read_b128 v[108:111], v21 offset:35040
    ds_read_b128 v[16:19], v21 offset:35072
    s_waitcnt lgkmcnt(3)
    v_add_u32 v100, v100, v20
    v_add_u32 v101, v101, v20
    v_add_u32 v102, v102, v20
    v_add_u32 v103, v103, v20
    buffer_load_dwordx4 v[48:51], v100, s[32:35], 0 offen
    buffer_load_dwordx4 v[52:55], v101, s[32:35], 0 offen
    buffer_load_dwordx4 v[56:59], v102, s[32:35], 0 offen
    buffer_load_dwordx4 v[60:63], v103, s[32:35], 0 offen
    s_waitcnt vmcnt(8)
    ds_read_b64_tr_b16 v[176:177], v124 offset:0
    ds_read_b64_tr_b16 v[178:179], v124 offset:512
    ds_read_b64_tr_b16 v[180:181], v125 offset:0
    ds_read_b64_tr_b16 v[182:183], v125 offset:512
    ds_read_b64_tr_b16 v[184:185], v126 offset:0
    ds_read_b64_tr_b16 v[186:187], v126 offset:512
    ds_read_b64_tr_b16 v[188:189], v127 offset:0
    ds_read_b64_tr_b16 v[190:191], v127 offset:512
    ds_read_b64_tr_b16 v[192:193], v124 offset:4096
    ds_read_b64_tr_b16 v[194:195], v124 offset:4608
    ds_read_b64_tr_b16 v[196:197], v125 offset:4096
    ds_read_b64_tr_b16 v[198:199], v125 offset:4608
    ds_read_b64_tr_b16 v[200:201], v126 offset:4096
    ds_read_b64_tr_b16 v[202:203], v126 offset:4608
    ds_read_b64_tr_b16 v[204:205], v127 offset:4096
    ds_read_b64_tr_b16 v[206:207], v127 offset:4608
    ds_read_b64_tr_b16 v[208:209], v124 offset:8192
    ds_read_b64_tr_b16 v[210:211], v124 offset:8704
    ds_read_b64_tr_b16 v[212:213], v125 offset:8192
    ds_read_b64_tr_b16 v[214:215], v125 offset:8704
    ds_read_b64_tr_b16 v[216:217], v126 offset:8192
    ds_read_b64_tr_b16 v[218:219], v126 offset:8704
    ds_read_b64_tr_b16 v[220:221], v127 offset:8192
    ds_read_b64_tr_b16 v[222:223], v127 offset:8704
    s_waitcnt lgkmcnt(0)
    v_add_u32 v104, v104, v20
    v_add_u32 v105, v105, v20
    v_add_u32 v106, v106, v20
    v_add_u32 v107, v107, v20
    buffer_load_dwordx4 v[64:67], v104, s[32:35], 0 offen
    buffer_load_dwordx4 v[68:71], v105, s[32:35], 0 offen
    buffer_load_dwordx4 v[72:75], v106, s[32:35], 0 offen
    buffer_load_dwordx4 v[76:79], v107, s[32:35], 0 offen
    s_waitcnt lgkmcnt(0)
    v_add_u32 v108, v108, v20
    v_add_u32 v109, v109, v20
    v_add_u32 v110, v110, v20
    v_add_u32 v111, v111, v20
    buffer_load_dwordx4 v[80:83], v108, s[32:35], 0 offen
    buffer_load_dwordx4 v[84:87], v109, s[32:35], 0 offen
    buffer_load_dwordx4 v[88:91], v110, s[32:35], 0 offen
    buffer_load_dwordx4 v[92:95], v111, s[32:35], 0 offen
L_gloop:
    s_cmp_lt_u32 s80, 4
    s_cbranch_scc1 L_dr_3
    s_waitcnt vmcnt(12)
L_go_2:
    v_mfma_f32_16x16x32_bf16 v[12:15], v[8:11], v[32:35], v[12:15]
    s_bitcmp1_b32 s76, 0
    s_cbranch_scc1 L_st_5
L_bk_6:
    v_mfma_f32_16x16x32_bf16 v[12:15], v[8:11], v[36:39], v[12:15]
    s_bitcmp1_b32 s76, 1
    s_cbranch_scc1 L_st_7
L_bk_8:
    v_mfma_f32_16x16x32_bf16 v[12:15], v[8:11], v[40:43], v[12:15]
    s_bitcmp1_b32 s76, 2
    s_cbranch_scc1 L_st_9
L_bk_10:
    v_mfma_f32_16x16x32_bf16 v[12:15], v[8:11], v[44:47], v[12:15]
    s_bitcmp1_b32 s76, 3
    s_cbranch_scc1 L_st_11
L_bk_12:
    s_cmp_lt_u32 s80, 5
    s_cbranch_scc1 L_ni_4
    s_waitcnt lgkmcnt(0)
    v_add_u32 v16, v16, v20
    v_add_u32 v17, v17, v20
    v_add_u32 v18, v18, v20
    v_add_u32 v19, v19, v20
    buffer_load_dwordx4 v[32:35], v16, s[32:35], 0 offen
    buffer_load_dwordx4 v[36:39], v17, s[32:35], 0 offen
    buffer_load_dwordx4 v[40:43], v18, s[32:35], 0 offen
    buffer_load_dwordx4 v[44:47], v19, s[32:35], 0 offen
    ds_read_b128 v[16:19], v21 offset:35104
L_ni_4:
    s_sub_u32 s80, s80, 1
    s_cmp_lt_u32 s80, 4
    s_cbranch_scc1 L_dr_14
    s_waitcnt vmcnt(12)
L_go_13:
    v_mfma_f32_16x16x32_bf16 v[12:15], v[8:11], v[48:51], v[12:15]
    s_bitcmp1_b32 s76, 4
    s_cbranch_scc1 L_st_16
L_bk_17:
    v_mfma_f32_16x16x32_bf16 v[12:15], v[8:11], v[52:55], v[12:15]
    s_bitcmp1_b32 s76, 5
    s_cbranch_scc1 L_st_18
L_bk_19:
    v_mfma_f32_16x16x32_bf16 v[12:15], v[8:11], v[56:59], v[12:15]
    s_bitcmp1_b32 s76, 6
    s_cbranch_scc1 L_st_20
L_bk_21:
    v_mfma_f32_16x16x32_bf16 v[12:15], v[8:11], v[60:63], v[12:15]
    s_bitcmp1_b32 s76, 7
    s_cbranch_scc1 L_st_22
L_bk_23:
    s_cmp_lt_u32 s80, 5
    s_cbranch_scc1 L_ni_15
    s_waitcnt lgkmcnt(0)
    v_add_u32 v16, v16, v20
    v_add_u32 v17, v17, v20
    v_add_u32 v18, v18, v20
    v_add_u32 v19, v19, v20
    buffer_load_dwordx4 v[48:51], v16, s[32:35], 0 offen
    buffer_load_dwordx4 v[52:55], v17, s[32:35], 0 offen
    buffer_load_dwordx4 v[56:59], v18, s[32:35], 0 offen
    buffer_load_dwordx4 v[60:63], v19, s[32:35], 0 offen
    ds_read_b128 v[16:19], v21 offset:35136
L_ni_15:
    s_sub_u32 s80, s80, 1
    s_cmp_lt_u32 s80, 4
    s_cbranch_scc1 L_dr_25
    s_waitcnt vmcnt(12)
L_go_24:
    v_mfma_f32_16x16x32_bf16 v[12:15], v[8:11], v[64:67], v[12:15]
    s_bitcmp1_b32 s76, 8
    s_cbranch_scc1 L_st_27
L_bk_28:
    v_mfma_f32_16x16x32_bf16 v[12:15], v[8:11], v[68:71], v[12:15]
    s_bitcmp1_b32 s76, 9
    s_cbranch_scc1 L_st_29
L_bk_30:
    v_mfma_f32_16x16x32_bf16 v[12:15], v[8:11], v[72:75], v[12:15]
    s_bitcmp1_b32 s76, 10
    s_cbranch_scc1 L_st_31
L_bk_32:
    v_mfma_f32_16x16x32_bf16 v[12:15], v[8:11], v[76:79], v[12:15]
    s_bitcmp1_b32 s76, 11
    s_cbranch_scc1 L_st_33
L_bk_34:
    s_cmp_lt_u32 s80, 5
    s_cbranch_scc1 L_ni_26
    s_waitcnt lgkmcnt(0)
    v_add_u32 v16, v16, v20
    v_add_u32 v17, v17, v20
    v_add_u32 v18, v18, v20
    v_add_u32 v19, v19, v20
    buffer_load_dwordx4 v[64:67], v16, s[32:35], 0 offen
    buffer_load_dwordx4 v[68:71], v17, s[32:35], 0 offen
    buffer_load_dwordx4 v[72:75], v18, s[32:35], 0 offen
    buffer_load_dwordx4 v[76:79], v19, s[32:35], 0 offen
    ds_read_b128 v[16:19], v21 offset:35168
L_ni_26:
    s_sub_u32 s80, s80, 1
    s_cmp_lt_u32 s80, 4
    s_cbranch_scc1 L_dr_36
    s_waitcnt vmcnt(12)
L_go_35:
    v_mfma_f32_16x16x32_bf16 v[12:15], v[8:11], v[80:83], v[12:15]
    s_bitcmp1_b32 s76, 12
    s_cbranch_scc1 L_st_38
L_bk_39:
    v_mfma_f32_16x16x32_bf16 v[12:15], v[8:11], v[84:87], v[12:15]
    s_bitcmp1_b32 s76, 13
    s_cbranch_scc1 L_st_40
L_bk_41:
    v_mfma_f32_16x16x32_bf16 v[12:15], v[8:11], v[88:91], v[12:15]
    s_bitcmp1_b32 s76, 14
    s_cbranch_scc1 L_st_42
L_bk_43:
    v_mfma_f32_16x16x32_bf16 v[12:15], v[8:11], v[92:95], v[12:15]
    s_bitcmp1_b32 s76, 15
    s_cbranch_scc1 L_st_44
L_bk_45:
    s_cmp_lt_u32 s80, 5
    s_cbranch_scc1 L_ni_37
    s_waitcnt lgkmcnt(0)
    v_add_u32 v16, v16, v20
    v_add_u32 v17, v17, v20
    v_add_u32 v18, v18, v20
    v_add_u32 v19, v19, v20
    buffer_load_dwordx4 v[80:83], v16, s[32:35], 0 offen
    buffer_load_dwordx4 v[84:87], v17, s[32:35], 0 offen
    buffer_load_dwordx4 v[88:91], v18, s[32:35], 0 offen
    buffer_load_dwordx4 v[92:95], v19, s[32:35], 0 offen
    ds_read_b128 v[16:19], v21 offset:35200
L_ni_37:
    s_sub_u32 s80, s80, 1
    v_add_u32 v21, 128, v21
    s_lshr_b64 s[76:77], s[76:77], 16
    s_add_u32 s81, s81, 1
    s_cmp_eq_u32 s81, 4
    s_cselect_b64 s[76:77], s[78:79], s[76:77]
    s_cmp_lt_u32 s81, 8
    s_cbranch_scc1 L_gloop
    s_endpgm
L_st_5:
    s_call_b64 s[88:89], L_fin
    s_branch L_bk_6
L_st_7:
    s_call_b64 s[88:89], L_fin
    s_branch L_bk_8
L_st_9:
    s_call_b64 s[88:89], L_fin
    s_branch L_bk_10
L_st_11:
    s_call_b64 s[88:89], L_fin
    s_branch L_bk_12
L_st_16:
    s_call_b64 s[88:89], L_fin
    s_branch L_bk_17
L_st_18:
    s_call_b64 s[88:89], L_fin
    s_branch L_bk_19
L_st_20:
    s_call_b64 s[88:89], L_fin
    s_branch L_bk_21
L_st_22:
    s_call_b64 s[88:89], L_fin
    s_branch L_bk_23
L_st_27:
    s_call_b64 s[88:89], L_fin
    s_branch L_bk_28
L_st_29:
    s_call_b64 s[88:89], L_fin
    s_branch L_bk_30
L_st_31:
    s_call_b64 s[88:89], L_fin
    s_branch L_bk_32
L_st_33:
    s_call_b64 s[88:89], L_fin
    s_branch L_bk_34
L_st_38:
    s_call_b64 s[88:89], L_fin
    s_branch L_bk_39
L_st_40:
    s_call_b64 s[88:89], L_fin
    s_branch L_bk_41
L_st_42:
    s_call_b64 s[88:89], L_fin
    s_branch L_bk_43
L_st_44:
    s_call_b64 s[88:89], L_fin
    s_branch L_bk_45
L_dr_3:
    s_cmp_lt_u32 s80, 3
    s_cbranch_scc1 L_dr_46
    s_waitcnt vmcnt(8)
    s_branch L_go_2
L_dr_46:
    s_cmp_lt_u32 s80, 2
    s_cbranch_scc1 L_dr_47
    s_waitcnt vmcnt(4)
    s_branch L_go_2
L_dr_47:
    s_waitcnt vmcnt(0)
    s_branch L_go_2
L_dr_14:
    s_cmp_lt_u32 s80, 3
    s_cbranch_scc1 L_dr_48
    s_waitcnt vmcnt(8)
    s_branch L_go_13
L_dr_48:
    s_cmp_lt_u32 s80, 2
    s_cbranch_scc1 L_dr_49
    s_waitcnt vmcnt(4)
    s_branch L_go_13
L_dr_49:
    s_waitcnt vmcnt(0)
    s_branch L_go_13
L_dr_25:
    s_cmp_lt_u32 s80, 3
    s_cbranch_scc1 L_dr_50
    s_waitcnt vmcnt(8)
    s_branch L_go_24
L_dr_50:
    s_cmp_lt_u32 s80, 2
    s_cbranch_scc1 L_dr_51
    s_waitcnt vmcnt(4)
    s_branch L_go_24
L_dr_51:
    s_waitcnt vmcnt(0)
    s_branch L_go_24
L_dr_36:
    s_cmp_lt_u32 s80, 3
    s_cbranch_scc1 L_dr_52
    s_waitcnt vmcnt(8)
    s_branch L_go_35
L_dr_52:
    s_cmp_lt_u32 s80, 2
    s_cbranch_scc1 L_dr_53
    s_waitcnt vmcnt(4)
    s_branch L_go_35
L_dr_53:
    s_waitcnt vmcnt(0)
    s_branch L_go_35
L_fin:
    s_and_b32 s64, s20, 0xff
    s_lshr_b64 s[20:21], s[20:21], 8
    s_and_b32 s65, s20, 0xff
    s_mul_i32 s64, s64, 528
    s_mul_i32 s65, s65, 528
    s_waitcnt lgkmcnt(0)
    v_lshlrev_b32 v4, 16, v30
    v_and_b32 v5, 0xffff0000, v30
    v_lshlrev_b32 v6, 16, v31
    v_and_b32 v7, 0xffff0000, v31
    v_add_u32 v27, s65, v22
    ds_read_b64 v[30:31], v27 offset:13824
    v_fma_f32 v4, v4, s86, v12
    v_fma_f32 v5, v5, s86, v13
    v_fma_f32 v6, v6, s86, v14
    v_fma_f32 v7, v7, s86, v15
    v_add_u32 v27, s64, v22
    v_cvt_pk_bf16_f32 v4, v4, v5
    v_cvt_pk_bf16_f32 v5, v6, v7
    v_mov_b32 v12, 0
    v_mov_b32 v13, 0
    ds_write_b64 v27, v[4:5] offset:13824
    v_mov_b32 v14, 0
    v_mov_b32 v15, 0
    s_sub_u32 s82, s82, 1
    s_cmp_eq_u32 s82, 2
    s_cbranch_scc1 L_finflag
    s_cmp_eq_u32 s82, 0
    s_cbranch_scc1 L_gdone
    s_setpc_b64 s[88:89]
L_finflag:
    buffer_load_dwordx4 v[124:127], v28, s[56:59], s100 offen sc1
    s_setpc_b64 s[88:89]
L_gdone:
    v_mov_b32 v7, s101
    v_mov_b32 v27, 1
    s_mov_b64 exec, 1
    ds_add_u32 v7, v27 offset:264
    s_mov_b64 exec, -1
    s_cmp_ge_u32 s60, 4
    s_cbranch_scc1 L_noarr
    s_setprio 0
L_noarr:
    s_mov_b32 s66, 0
    s_mul_i32 s63, s30, 2654435761
    s_mul_i32 s64, s30, 2246822519
L_chk2:
    s_waitcnt vmcnt(0)
    v_xor_b32 v124, s63, v124
    v_xor_b32 v125, s63, v125
    v_xor_b32 v126, s63, v126
    v_xor_b32 v127, s63, v127
    v_or3_b32 v5, v124, v125, v126
    v_or_b32 v5, v5, v127
    s_mov_b32 exec_hi, 0xffff
    v_cmp_ne_u32 vcc, 0, v5
    s_mov_b64 exec, -1
    s_cbranch_vccnz L_w2miss
L_w2ok:
    v_add_u32 v3, s67, v28
    ds_read_b128 v[48:51], v29 offset:512
    ds_read_b128 v[52:55], v29 offset:576
    ds_read_b128 v[56:59], v29 offset:640
    ds_read_b128 v[60:63], v29 offset:704
    s_mov_b32 s66, 0
    v_mov_b32 v27, 0
    s_branch L_spA_in
L_spA:
    s_sleep 1
L_spA_in:
    ds_read_b32 v7, v27 offset:264
    s_add_u32 s66, s66, 1
    s_waitcnt lgkmcnt(0)
    v_readfirstlane_b32 s64, v7
    s_cmp_lt_u32 s66, 0x4000000
    s_cselect_b32 s65, 4, 0
    s_cmp_lt_u32 s64, s65
    s_cbranch_scc1 L_spA
    ds_read_b128 v[64:67], v23 offset:13824
    ds_read_b128 v[68:71], v23 offset:30720
    ds_read_b128 v[72:75], v23 offset:13856
    ds_read_b128 v[76:79], v23 offset:30752
    ds_read_b128 v[80:83], v23 offset:13888
    ds_read_b128 v[84:87], v23 offset:30784
    s_waitcnt lgkmcnt(4)
    v_mfma_f32_16x16x32_bf16 v[32:35], v[128:131], v[64:67], v[48:51]
    v_mfma_f32_16x16x32_bf16 v[36:39], v[132:135], v[64:67], v[52:55]
    v_mfma_f32_16x16x32_bf16 v[40:43], v[136:139], v[64:67], v[56:59]
    v_mfma_f32_16x16x32_bf16 v[44:47], v[140:143], v[64:67], v[60:63]
    v_mfma_f32_16x16x32_bf16 v[48:51], v[128:131], v[68:71], v[48:51]
    v_mfma_f32_16x16x32_bf16 v[52:55], v[132:135], v[68:71], v[52:55]
    v_mfma_f32_16x16x32_bf16 v[56:59], v[136:139], v[68:71], v[56:59]
    v_mfma_f32_16x16x32_bf16 v[60:63], v[140:143], v[68:71], v[60:63]
    s_lshl_b32 s97, s74, 1
    s_add_u32 s97, s97, 262144
    buffer_load_dwordx4 v[224:227], v3, s[56:59], s97 offen offset:0 sc1
    buffer_load_dwordx4 v[228:231], v3, s[56:59], s97 offen offset:1024 sc1
    buffer_load_dwordx4 v[232:235], v3, s[56:59], s97 offen offset:2048 sc1
    buffer_load_dwordx4 v[236:239], v3, s[56:59], s97 offen offset:3072 sc1
    ds_read_b128 v[64:67], v23 offset:13920
    ds_read_b128 v[68:71], v23 offset:30816
    s_waitcnt lgkmcnt(4)
    v_mfma_f32_16x16x32_bf16 v[32:35], v[144:147], v[72:75], v[32:35]
    v_mfma_f32_16x16x32_bf16 v[36:39], v[148:151], v[72:75], v[36:39]
    v_mfma_f32_16x16x32_bf16 v[40:43], v[152:155], v[72:75], v[40:43]
    v_mfma_f32_16x16x32_bf16 v[44:47], v[156:159], v[72:75], v[44:47]
    v_mfma_f32_16x16x32_bf16 v[48:51], v[144:147], v[76:79], v[48:51]
    v_mfma_f32_16x16x32_bf16 v[52:55], v[148:151], v[76:79], v[52:55]
    v_mfma_f32_16x16x32_bf16 v[56:59], v[152:155], v[76:79], v[56:59]
    v_mfma_f32_16x16x32_bf16 v[60:63], v[156:159], v[76:79], v[60:63]
    s_lshl_b32 s97, s75, 1
    s_add_u32 s97, s97, 262144
    buffer_load_dwordx4 v[240:243], v3, s[56:59], s97 offen offset:0 sc1
    buffer_load_dwordx4 v[244:247], v3, s[56:59], s97 offen offset:1024 sc1
    buffer_load_dwordx4 v[248:251], v3, s[56:59], s97 offen offset:2048 sc1
    buffer_load_dwordx4 v[252:255], v3, s[56:59], s97 offen offset:3072 sc1
    ds_read_b128 v[72:75], v23 offset:13952
    ds_read_b128 v[76:79], v23 offset:30848
    s_waitcnt lgkmcnt(4)
    v_mfma_f32_16x16x32_bf16 v[32:35], v[160:163], v[80:83], v[32:35]
    v_mfma_f32_16x16x32_bf16 v[36:39], v[164:167], v[80:83], v[36:39]
    v_mfma_f32_16x16x32_bf16 v[40:43], v[168:171], v[80:83], v[40:43]
    v_mfma_f32_16x16x32_bf16 v[44:47], v[172:175], v[80:83], v[44:47]
    buffer_load_dwordx4 v[88:91], v3, s[56:59], s68 offen offset:0 sc1
    v_mfma_f32_16x16x32_bf16 v[48:51], v[160:163], v[84:87], v[48:51]
    v_mfma_f32_16x16x32_bf16 v[52:55], v[164:167], v[84:87], v[52:55]
    v_mfma_f32_16x16x32_bf16 v[56:59], v[168:171], v[84:87], v[56:59]
    v_mfma_f32_16x16x32_bf16 v[60:63], v[172:175], v[84:87], v[60:63]
    buffer_load_dwordx4 v[92:95], v3, s[56:59], s68 offen offset:1024 sc1
    ds_read_b128 v[80:83], v23 offset:13984
    ds_read_b128 v[84:87], v23 offset:30880
    s_waitcnt lgkmcnt(4)
    v_mfma_f32_16x16x32_bf16 v[32:35], v[176:179], v[64:67], v[32:35]
    v_mfma_f32_16x16x32_bf16 v[36:39], v[180:183], v[64:67], v[36:39]
    v_mfma_f32_16x16x32_bf16 v[40:43], v[184:187], v[64:67], v[40:43]
    v_mfma_f32_16x16x32_bf16 v[44:47], v[188:191], v[64:67], v[44:47]
    buffer_load_dwordx4 v[96:99], v3, s[56:59], s69 offen offset:0 sc1
    v_mfma_f32_16x16x32_bf16 v[48:51], v[176:179], v[68:71], v[48:51]
    v_mfma_f32_16x16x32_bf16 v[52:55], v[180:183], v[68:71], v[52:55]
    v_mfma_f32_16x16x32_bf16 v[56:59], v[184:187], v[68:71], v[56:59]
    v_mfma_f32_16x16x32_bf16 v[60:63], v[188:191], v[68:71], v[60:63]
    buffer_load_dwordx4 v[100:103], v3, s[56:59], s69 offen offset:1024 sc1
    ds_read_b128 v[64:67], v23 offset:14016
    ds_read_b128 v[68:71], v23 offset:30912
    s_waitcnt lgkmcnt(4)
    v_mfma_f32_16x16x32_bf16 v[32:35], v[192:195], v[72:75], v[32:35]
    v_mfma_f32_16x16x32_bf16 v[36:39], v[196:199], v[72:75], v[36:39]
    v_mfma_f32_16x16x32_bf16 v[40:43], v[200:203], v[72:75], v[40:43]
    v_mfma_f32_16x16x32_bf16 v[44:47], v[204:207], v[72:75], v[44:47]
    buffer_load_dwordx4 v[104:107], v3, s[56:59], s70 offen offset:0 sc1
    v_mfma_f32_16x16x32_bf16 v[48:51], v[192:195], v[76:79], v[48:51]
    v_mfma_f32_16x16x32_bf16 v[52:55], v[196:199], v[76:79], v[52:55]
    v_mfma_f32_16x16x32_bf16 v[56:59], v[200:203], v[76:79], v[56:59]
    v_mfma_f32_16x16x32_bf16 v[60:63], v[204:207], v[76:79], v[60:63]
    buffer_load_dwordx4 v[108:111], v3, s[56:59], s70 offen offset:1024 sc1
    ds_read_b128 v[72:75], v23 offset:14048
    ds_read_b128 v[76:79], v23 offset:30944
    s_waitcnt lgkmcnt(4)
    v_mfma_f32_16x16x32_bf16 v[32:35], v[208:211], v[80:83], v[32:35]
    v_mfma_f32_16x16x32_bf16 v[36:39], v[212:215], v[80:83], v[36:39]
    v_mfma_f32_16x16x32_bf16 v[40:43], v[216:219], v[80:83], v[40:43]
    v_mfma_f32_16x16x32_bf16 v[44:47], v[220:223], v[80:83], v[44:47]
    buffer_load_dwordx4 v[112:115], v3, s[56:59], s71 offen offset:0 sc1
    v_mfma_f32_16x16x32_bf16 v[48:51], v[208:211], v[84:87], v[48:51]
    v_mfma_f32_16x16x32_bf16 v[52:55], v[212:215], v[84:87], v[52:55]
    v_mfma_f32_16x16x32_bf16 v[56:59], v[216:219], v[84:87], v[56:59]
    v_mfma_f32_16x16x32_bf16 v[60:63], v[220:223], v[84:87], v[60:63]
    buffer_load_dwordx4 v[116:119], v3, s[56:59], s71 offen offset:1024 sc1
    s_waitcnt vmcnt(12) lgkmcnt(2)
    v_mfma_f32_16x16x32_bf16 v[32:35], v[224:227], v[64:67], v[32:35]
    v_mfma_f32_16x16x32_bf16 v[36:39], v[228:231], v[64:67], v[36:39]
    v_mfma_f32_16x16x32_bf16 v[40:43], v[232:235], v[64:67], v[40:43]
    v_mfma_f32_16x16x32_bf16 v[44:47], v[236:239], v[64:67], v[44:47]
    buffer_load_dwordx4 v[120:123], v3, s[56:59], s72 offen offset:0 sc1
    v_mfma_f32_16x16x32_bf16 v[48:51], v[224:227], v[68:71], v[48:51]
    v_mfma_f32_16x16x32_bf16 v[52:55], v[228:231], v[68:71], v[52:55]
    v_mfma_f32_16x16x32_bf16 v[56:59], v[232:235], v[68:71], v[56:59]
    v_mfma_f32_16x16x32_bf16 v[60:63], v[236:239], v[68:71], v[60:63]
    buffer_load_dwordx4 v[124:127], v3, s[56:59], s72 offen offset:1024 sc1
    s_waitcnt vmcnt(10) lgkmcnt(0)
    v_mfma_f32_16x16x32_bf16 v[32:35], v[240:243], v[72:75], v[32:35]
    v_mfma_f32_16x16x32_bf16 v[36:39], v[244:247], v[72:75], v[36:39]
    v_mfma_f32_16x16x32_bf16 v[40:43], v[248:251], v[72:75], v[40:43]
    v_mfma_f32_16x16x32_bf16 v[44:47], v[252:255], v[72:75], v[44:47]
    v_mfma_f32_16x16x32_bf16 v[48:51], v[240:243], v[76:79], v[48:51]
    v_mfma_f32_16x16x32_bf16 v[52:55], v[244:247], v[76:79], v[52:55]
    v_mfma_f32_16x16x32_bf16 v[56:59], v[248:251], v[76:79], v[56:59]
    v_mfma_f32_16x16x32_bf16 v[60:63], v[252:255], v[76:79], v[60:63]
    s_nop 6
    v_cvt_pk_bf16_f32 v64, v32, v33
    v_pk_max_i16 v64, v64, 0
    v_cvt_pk_bf16_f32 v65, v34, v35
    v_pk_max_i16 v65, v65, 0
    v_cvt_pk_bf16_f32 v66, v36, v37
    v_pk_max_i16 v66, v66, 0
    v_cvt_pk_bf16_f32 v67, v38, v39
    v_pk_max_i16 v67, v67, 0
    ds_write_b128 v24, v[64:67] offset:0
    v_cvt_pk_bf16_f32 v68, v40, v41
    v_pk_max_i16 v68, v68, 0
    v_cvt_pk_bf16_f32 v69, v42, v43
    v_pk_max_i16 v69, v69, 0
    v_cvt_pk_bf16_f32 v70, v44, v45
    v_pk_max_i16 v70, v70, 0
    v_cvt_pk_bf16_f32 v71, v46, v47
    v_pk_max_i16 v71, v71, 0
    ds_write_b128 v2, v[68:71] offset:0
    s_mov_b32 exec_lo, 0x00ff00ff
    s_mov_b32 exec_hi, 0x00ff00ff
    v_cvt_pk_bf16_f32 v72, v48, v49
    v_pk_max_i16 v72, v72, 0
    v_cvt_pk_bf16_f32 v73, v50, v51
    v_pk_max_i16 v73, v73, 0
    v_cvt_pk_bf16_f32 v74, v52, v53
    v_pk_max_i16 v74, v74, 0
    v_cvt_pk_bf16_f32 v75, v54, v55
    v_pk_max_i16 v75, v75, 0
    ds_write_b128 v24, v[72:75] offset:16640
    v_cvt_pk_bf16_f32 v76, v56, v57
    v_pk_max_i16 v76, v76, 0
    v_cvt_pk_bf16_f32 v77, v58, v59
    v_pk_max_i16 v77, v77, 0
    v_cvt_pk_bf16_f32 v78, v60, v61
    v_pk_max_i16 v78, v78, 0
    v_cvt_pk_bf16_f32 v79, v62, v63
    v_pk_max_i16 v79, v79, 0
    ds_write_b128 v2, v[76:79] offset:16640
    s_mov_b64 exec, -1
    ds_read_b128 v[32:35], v29 offset:512
    ds_read_b128 v[36:39], v29 offset:576
    ds_read_b128 v[40:43], v29 offset:640
    ds_read_b128 v[44:47], v29 offset:704
    s_mov_b32 s66, 0
    v_mov_b32 v27, 0
    s_branch L_spB_in
L_spB:
    s_sleep 1
L_spB_in:
    ds_read_b32 v7, v27 offset:268
    s_add_u32 s66, s66, 1
    s_waitcnt lgkmcnt(0)
    v_readfirstlane_b32 s64, v7
    s_cmp_lt_u32 s66, 0x4000000
    s_cselect_b32 s65, 4, 0
    s_cmp_lt_u32 s64, s65
    s_cbranch_scc1 L_spB
    ds_read_b128 v[64:67], v23 offset:22272
    ds_read_b128 v[72:75], v23 offset:22304
    ds_read_b128 v[80:83], v23 offset:22336
    s_waitcnt lgkmcnt(2)
    v_mfma_f32_16x16x32_bf16 v[32:35], v[128:131], v[64:67], v[32:35]
    v_mfma_f32_16x16x32_bf16 v[36:39], v[132:135], v[64:67], v[36:39]
    v_mfma_f32_16x16x32_bf16 v[40:43], v[136:139], v[64:67], v[40:43]
    v_mfma_f32_16x16x32_bf16 v[44:47], v[140:143], v[64:67], v[44:47]
    ds_read_b128 v[64:67], v23 offset:22368
    buffer_load_dwordx4 v[128:131], v3, s[56:59], s73 offen offset:0 sc1
    s_waitcnt lgkmcnt(2)
    v_mfma_f32_16x16x32_bf16 v[32:35], v[144:147], v[72:75], v[32:35]
    v_mfma_f32_16x16x32_bf16 v[36:39], v[148:151], v[72:75], v[36:39]
    v_mfma_f32_16x16x32_bf16 v[40:43], v[152:155], v[72:75], v[40:43]
    v_mfma_f32_16x16x32_bf16 v[44:47], v[156:159], v[72:75], v[44:47]
    ds_read_b128 v[72:75], v23 offset:22400
    buffer_load_dwordx4 v[132:135], v3, s[56:59], s73 offen offset:1024 sc1
    s_waitcnt lgkmcnt(2)
    v_mfma_f32_16x16x32_bf16 v[32:35], v[160:163], v[80:83], v[32:35]
    v_mfma_f32_16x16x32_bf16 v[36:39], v[164:167], v[80:83], v[36:39]
    v_mfma_f32_16x16x32_bf16 v[40:43], v[168:171], v[80:83], v[40:43]
    v_mfma_f32_16x16x32_bf16 v[44:47], v[172:175], v[80:83], v[44:47]
    ds_read_b128 v[80:83], v23 offset:22432
    buffer_load_dwordx4 v[136:139], v3, s[56:59], s74 offen offset:0 sc1
    s_waitcnt lgkmcnt(2)
    v_mfma_f32_16x16x32_bf16 v[32:35], v[176:179], v[64:67], v[32:35]
    v_mfma_f32_16x16x32_bf16 v[36:39], v[180:183], v[64:67], v[36:39]
    v_mfma_f32_16x16x32_bf16 v[40:43], v[184:187], v[64:67], v[40:43]
    v_mfma_f32_16x16x32_bf16 v[44:47], v[188:191], v[64:67], v[44:47]
    ds_read_b128 v[64:67], v23 offset:22464
    buffer_load_dwordx4 v[140:143], v3, s[56:59], s74 offen offset:1024 sc1
    s_waitcnt lgkmcnt(2)
    v_mfma_f32_16x16x32_bf16 v[32:35], v[192:195], v[72:75], v[32:35]
    v_mfma_f32_16x16x32_bf16 v[36:39], v[196:199], v[72:75], v[36:39]
    v_mfma_f32_16x16x32_bf16 v[40:43], v[200:203], v[72:75], v[40:43]
    v_mfma_f32_16x16x32_bf16 v[44:47], v[204:207], v[72:75], v[44:47]
    ds_read_b128 v[72:75], v23 offset:22496
    buffer_load_dwordx4 v[144:147], v3, s[56:59], s75 offen offset:0 sc1
    s_waitcnt lgkmcnt(2)
    v_mfma_f32_16x16x32_bf16 v[32:35], v[208:211], v[80:83], v[32:35]
    v_mfma_f32_16x16x32_bf16 v[36:39], v[212:215], v[80:83], v[36:39]
    v_mfma_f32_16x16x32_bf16 v[40:43], v[216:219], v[80:83], v[40:43]
    v_mfma_f32_16x16x32_bf16 v[44:47], v[220:223], v[80:83], v[44:47]
    buffer_load_dwordx4 v[148:151], v3, s[56:59], s75 offen offset:1024 sc1
    v_add_u32 v3, 16384, v3
    s_waitcnt lgkmcnt(1)
    v_mfma_f32_16x16x32_bf16 v[32:35], v[224:227], v[64:67], v[32:35]
    v_mfma_f32_16x16x32_bf16 v[36:39], v[228:231], v[64:67], v[36:39]
    v_mfma_f32_16x16x32_bf16 v[40:43], v[232:235], v[64:67], v[40:43]
    v_mfma_f32_16x16x32_bf16 v[44:47], v[236:239], v[64:67], v[44:47]
    buffer_load_dwordx4 v[152:155], v3, s[56:59], s68 offen offset:0 sc1
    s_waitcnt lgkmcnt(0)
    v_mfma_f32_16x16x32_bf16 v[32:35], v[240:243], v[72:75], v[32:35]
    v_mfma_f32_16x16x32_bf16 v[36:39], v[244:247], v[72:75], v[36:39]
    v_mfma_f32_16x16x32_bf16 v[40:43], v[248:251], v[72:75], v[40:43]
    v_mfma_f32_16x16x32_bf16 v[44:47], v[252:255], v[72:75], v[44:47]
    buffer_load_dwordx4 v[156:159], v3, s[56:59], s68 offen offset:1024 sc1
    s_nop 6
    v_cvt_pk_bf16_f32 v64, v32, v33
    v_pk_max_i16 v64, v64, 0
    v_cvt_pk_bf16_f32 v65, v34, v35
    v_pk_max_i16 v65, v65, 0
    v_cvt_pk_bf16_f32 v66, v36, v37
    v_pk_max_i16 v66, v66, 0
    v_cvt_pk_bf16_f32 v67, v38, v39
    v_pk_max_i16 v67, v67, 0
    ds_write_b128 v24, v[64:67] offset:24960
    v_cvt_pk_bf16_f32 v68, v40, v41
    v_pk_max_i16 v68, v68, 0
    v_cvt_pk_bf16_f32 v69, v42, v43
    v_pk_max_i16 v69, v69, 0
    v_cvt_pk_bf16_f32 v70, v44, v45
    v_pk_max_i16 v70, v70, 0
    v_cvt_pk_bf16_f32 v71, v46, v47
    v_pk_max_i16 v71, v71, 0
    ds_write_b128 v2, v[68:71] offset:24960
    v_mov_b32 v7, s101
    v_mov_b32 v27, 1
    s_mov_b64 exec, 1
    ds_add_u32 v7, v27 offset:272
    s_mov_b64 exec, -1
    s_lshl_b32 s63, s60, 8
    v_subrev_u32 v4, s63, v29
    v_lshlrev_b32 v4, 1, v4
    s_lshl_b32 s63, s60, 7
    v_add_u32 v4, s63, v4
    ds_read_b128 v[48:51], v4 offset:2560
    ds_read_b128 v[52:55], v4 offset:2576
    buffer_load_dwordx4 v[160:163], v3, s[56:59], s69 offen offset:0 sc1
    buffer_load_dwordx4 v[164:167], v3, s[56:59], s69 offen offset:1024 sc1
    s_mov_b32 s66, 0
    v_mov_b32 v27, 0
    s_branch L_spG0_in
L_spG0:
    s_sleep 1
L_spG0_in:
    ds_read_b32 v7, v27 offset:272
    s_add_u32 s66, s66, 1
    s_waitcnt lgkmcnt(0)
    v_readfirstlane_b32 s64, v7
    s_cmp_lt_u32 s66, 0x4000000
    s_cselect_b32 s65, 4, 0
    s_cmp_lt_u32 s64, s65
    s_cbranch_scc1 L_spG0
    ds_read_b128 v[56:59], v25 offset:0
    ds_read_b128 v[60:63], v25 offset:24960
    ds_read_b128 v[64:67], v25 offset:16640
    ds_read_b128 v[68:71], v25 offset:32
    ds_read_b128 v[72:75], v25 offset:24992
    ds_read_b128 v[76:79], v25 offset:16672
    s_waitcnt vmcnt(18) lgkmcnt(3)
    v_mfma_f32_16x16x32_bf16 v[32:35], v[88:91], v[56:59], v[48:51]
    v_mfma_f32_16x16x32_bf16 v[36:39], v[92:95], v[56:59], v[52:55]
    buffer_load_dwordx4 v[168:171], v3, s[56:59], s70 offen offset:0 sc1
    v_mfma_f32_16x16x32_bf16 v[40:43], v[88:91], v[60:63], v[48:51]
    v_mfma_f32_16x16x32_bf16 v[44:47], v[92:95], v[60:63], v[52:55]
    buffer_load_dwordx4 v[172:175], v3, s[56:59], s70 offen offset:1024 sc1
    v_mfma_f32_16x16x32_bf16 v[48:51], v[88:91], v[64:67], v[48:51]
    v_mfma_f32_16x16x32_bf16 v[52:55], v[92:95], v[64:67], v[52:55]
    ds_read_b128 v[56:59], v25 offset:64
    ds_read_b128 v[60:63], v25 offset:25024
    ds_read_b128 v[64:67], v25 offset:16704
    s_waitcnt vmcnt(18) lgkmcnt(3)
    v_mfma_f32_16x16x32_bf16 v[32:35], v[96:99], v[68:71], v[32:35]
    v_mfma_f32_16x16x32_bf16 v[36:39], v[100:103], v[68:71], v[36:39]
    buffer_load_dwordx4 v[176:179], v3, s[56:59], s71 offen offset:0 sc1
    v_mfma_f32_16x16x32_bf16 v[40:43], v[96:99], v[72:75], v[40:43]
    v_mfma_f32_16x16x32_bf16 v[44:47], v[100:103], v[72:75], v[44:47]
    buffer_load_dwordx4 v[180:183], v3, s[56:59], s71 offen offset:1024 sc1
    v_mfma_f32_16x16x32_bf16 v[48:51], v[96:99], v[76:79], v[48:51]
    v_mfma_f32_16x16x32_bf16 v[52:55], v[100:103], v[76:79], v[52:55]
    ds_read_b128 v[68:71], v25 offset:96
    ds_read_b128 v[72:75], v25 offset:25056
    ds_read_b128 v[76:79], v25 offset:16736
    s_waitcnt vmcnt(18) lgkmcnt(3)
    v_mfma_f32_16x16x32_bf16 v[32:35], v[104:107], v[56:59], v[32:35]
    v_mfma_f32_16x16x32_bf16 v[36:39], v[108:111], v[56:59], v[36:39]
    buffer_load_dwordx4 v[184:187], v3, s[56:59], s72 offen offset:0 sc1
    v_mfma_f32_16x16x32_bf16 v[40:43], v[104:107], v[60:63], v[40:43]
    v_mfma_f32_16x16x32_bf16 v[44:47], v[108:111], v[60:63], v[44:47]
    buffer_load_dwordx4 v[188:191], v3, s[56:59], s72 offen offset:1024 sc1
    v_mfma_f32_16x16x32_bf16 v[48:51], v[104:107], v[64:67], v[48:51]
    v_mfma_f32_16x16x32_bf16 v[52:55], v[108:111], v[64:67], v[52:55]
    ds_read_b128 v[56:59], v25 offset:128
    ds_read_b128 v[60:63], v25 offset:25088
    ds_read_b128 v[64:67], v25 offset:16768
    s_waitcnt vmcnt(18) lgkmcnt(3)
    v_mfma_f32_16x16x32_bf16 v[32:35], v[112:115], v[68:71], v[32:35]
    v_mfma_f32_16x16x32_bf16 v[36:39], v[116:119], v[68:71], v[36:39]
    buffer_load_dwordx4 v[192:195], v3, s[56:59], s73 offen offset:0 sc1
    v_mfma_f32_16x16x32_bf16 v[40:43], v[112:115], v[72:75], v[40:43]
    v_mfma_f32_16x16x32_bf16 v[44:47], v[116:119], v[72:75], v[44:47]
    buffer_load_dwordx4 v[196:199], v3, s[56:59], s73 offen offset:1024 sc1
    v_mfma_f32_16x16x32_bf16 v[48:51], v[112:115], v[76:79], v[48:51]
    v_mfma_f32_16x16x32_bf16 v[52:55], v[116:119], v[76:79], v[52:55]
    ds_read_b128 v[68:71], v25 offset:160
    ds_read_b128 v[72:75], v25 offset:25120
    ds_read_b128 v[76:79], v25 offset:16800
    s_waitcnt vmcnt(18) lgkmcnt(3)
    v_mfma_f32_16x16x32_bf16 v[32:35], v[120:123], v[56:59], v[32:35]
    v_mfma_f32_16x16x32_bf16 v[36:39], v[124:127], v[56:59], v[36:39]
    buffer_load_dwordx4 v[200:203], v3, s[56:59], s74 offen offset:0 sc1
    v_mfma_f32_16x16x32_bf16 v[40:43], v[120:123], v[60:63], v[40:43]
    v_mfma_f32_16x16x32_bf16 v[44:47], v[124:127], v[60:63], v[44:47]
    buffer_load_dwordx4 v[204:207], v3, s[56:59], s74 offen offset:1024 sc1
    v_mfma_f32_16x16x32_bf16 v[48:51], v[120:123], v[64:67], v[48:51]
    v_mfma_f32_16x16x32_bf16 v[52:55], v[124:127], v[64:67], v[52:55]
    ds_read_b128 v[56:59], v25 offset:192
    ds_read_b128 v[60:63], v25 offset:25152
    ds_read_b128 v[64:67], v25 offset:16832
    s_waitcnt vmcnt(18) lgkmcnt(3)
    v_mfma_f32_16x16x32_bf16 v[32:35], v[128:131], v[68:71], v[32:35]
    v_mfma_f32_16x16x32_bf16 v[36:39], v[132:135], v[68:71], v[36:39]
    buffer_load_dwordx4 v[208:211], v3, s[56:59], s75 offen offset:0 sc1
    v_mfma_f32_16x16x32_bf16 v[40:43], v[128:131], v[72:75], v[40:43]
    v_mfma_f32_16x16x32_bf16 v[44:47], v[132:135], v[72:75], v[44:47]
    buffer_load_dwordx4 v[212:215], v3, s[56:59], s75 offen offset:1024 sc1
    v_mfma_f32_16x16x32_bf16 v[48:51], v[128:131], v[76:79], v[48:51]
    v_mfma_f32_16x16x32_bf16 v[52:55], v[132:135], v[76:79], v[52:55]
    ds_read_b128 v[68:71], v25 offset:224
    ds_read_b128 v[72:75], v25 offset:25184
    ds_read_b128 v[76:79], v25 offset:16864
    s_waitcnt vmcnt(18) lgkmcnt(3)
    v_mfma_f32_16x16x32_bf16 v[32:35], v[136:139], v[56:59], v[32:35]
    v_mfma_f32_16x16x32_bf16 v[36:39], v[140:143], v[56:59], v[36:39]
    v_mfma_f32_16x16x32_bf16 v[40:43], v[136:139], v[60:63], v[40:43]
    v_mfma_f32_16x16x32_bf16 v[44:47], v[140:143], v[60:63], v[44:47]
    v_mfma_f32_16x16x32_bf16 v[48:51], v[136:139], v[64:67], v[48:51]
    v_mfma_f32_16x16x32_bf16 v[52:55], v[140:143], v[64:67], v[52:55]
    s_waitcnt vmcnt(16) lgkmcnt(0)
    v_mfma_f32_16x16x32_bf16 v[32:35], v[144:147], v[68:71], v[32:35]
    v_mfma_f32_16x16x32_bf16 v[36:39], v[148:151], v[68:71], v[36:39]
    v_mfma_f32_16x16x32_bf16 v[40:43], v[144:147], v[72:75], v[40:43]
    v_mfma_f32_16x16x32_bf16 v[44:47], v[148:151], v[72:75], v[44:47]
    v_mfma_f32_16x16x32_bf16 v[48:51], v[144:147], v[76:79], v[48:51]
    v_mfma_f32_16x16x32_bf16 v[52:55], v[148:151], v[76:79], v[52:55]
    s_mov_b32 s90, 8192
    s_mov_b32 s91, 16384
    s_mov_b32 s66, 0
    v_mov_b32 v27, 0
    s_branch L_spG1_in
L_spG1:
    s_sleep 1
L_spG1_in:
    ds_read_b32 v7, v27 offset:276
    s_add_u32 s66, s66, 1
    s_waitcnt lgkmcnt(0)
    v_readfirstlane_b32 s64, v7
    s_cmp_lt_u32 s66, 0x4000000
    s_cselect_b32 s65, 4, 0
    s_cmp_lt_u32 s64, s65
    s_cbranch_scc1 L_spG1
    s_setprio 0
    ds_read_b128 v[56:59], v25 offset:512
    ds_read_b128 v[60:63], v25 offset:544
    ds_read_b128 v[64:67], v25 offset:576
    ds_read_b128 v[68:71], v25 offset:608
    ds_read_b128 v[72:75], v25 offset:640
    ds_read_b128 v[76:79], v25 offset:672
    s_waitcnt vmcnt(14) lgkmcnt(5)
    v_mfma_f32_16x16x32_bf16 v[32:35], v[152:155], v[56:59], v[32:35]
    v_mfma_f32_16x16x32_bf16 v[36:39], v[156:159], v[56:59], v[36:39]
    ds_read_b128 v[56:59], v25 offset:704
    s_waitcnt vmcnt(12) lgkmcnt(5)
    v_mfma_f32_16x16x32_bf16 v[32:35], v[160:163], v[60:63], v[32:35]
    v_mfma_f32_16x16x32_bf16 v[36:39], v[164:167], v[60:63], v[36:39]
    ds_read_b128 v[60:63], v25 offset:736
    s_waitcnt vmcnt(10) lgkmcnt(5)
    v_mfma_f32_16x16x32_bf16 v[32:35], v[168:171], v[64:67], v[32:35]
    v_mfma_f32_16x16x32_bf16 v[36:39], v[172:175], v[64:67], v[36:39]
    ds_read_b128 v[64:67], v25 offset:25472
    s_waitcnt vmcnt(8) lgkmcnt(5)
    v_mfma_f32_16x16x32_bf16 v[32:35], v[176:179], v[68:71], v[32:35]
    v_mfma_f32_16x16x32_bf16 v[36:39], v[180:183], v[68:71], v[36:39]
    ds_read_b128 v[68:71], v25 offset:25504
    s_waitcnt vmcnt(6) lgkmcnt(5)
    v_mfma_f32_16x16x32_bf16 v[32:35], v[184:187], v[72:75], v[32:35]
    v_mfma_f32_16x16x32_bf16 v[36:39], v[188:191], v[72:75], v[36:39]
    ds_read_b128 v[72:75], v25 offset:25536
    s_waitcnt vmcnt(4) lgkmcnt(5)
    v_mfma_f32_16x16x32_bf16 v[32:35], v[192:195], v[76:79], v[32:35]
    v_mfma_f32_16x16x32_bf16 v[36:39], v[196:199], v[76:79], v[36:39]
    ds_read_b128 v[76:79], v25 offset:25568
    s_waitcnt vmcnt(2) lgkmcnt(5)
    v_mfma_f32_16x16x32_bf16 v[32:35], v[200:203], v[56:59], v[32:35]
    v_mfma_f32_16x16x32_bf16 v[36:39], v[204:207], v[56:59], v[36:39]
    ds_read_b128 v[56:59], v25 offset:25600
    s_waitcnt vmcnt(0) lgkmcnt(5)
    v_mfma_f32_16x16x32_bf16 v[32:35], v[208:211], v[60:63], v[32:35]
    v_mfma_f32_16x16x32_bf16 v[36:39], v[212:215], v[60:63], v[36:39]
    ds_read_b128 v[60:63], v25 offset:25632
    s_waitcnt lgkmcnt(5)
    v_mfma_f32_16x16x32_bf16 v[40:43], v[152:155], v[64:67], v[40:43]
    v_mfma_f32_16x16x32_bf16 v[44:47], v[156:159], v[64:67], v[44:47]
    ds_read_b128 v[64:67], v25 offset:25664
    s_waitcnt lgkmcnt(5)
    v_mfma_f32_16x16x32_bf16 v[40:43], v[160:163], v[68:71], v[40:43]
    v_mfma_f32_16x16x32_bf16 v[44:47], v[164:167], v[68:71], v[44:47]
    ds_read_b128 v[68:71], v25 offset:25696
    s_waitcnt lgkmcnt(5)
    v_mfma_f32_16x16x32_bf16 v[40:43], v[168:171], v[72:75], v[40:43]
    v_mfma_f32_16x16x32_bf16 v[44:47], v[172:175], v[72:75], v[44:47]
    ds_read_b128 v[72:75], v25 offset:17152
    v_cvt_pk_bf16_f32 v88, v32, v36
    v_cvt_pk_bf16_f32 v89, v33, v37
    v_cvt_pk_bf16_f32 v90, v34, v38
    v_cvt_pk_bf16_f32 v91, v35, v39
    buffer_store_dwordx4 v[88:91], v0, s[52:55], 0 offen sc1
    s_waitcnt lgkmcnt(5)
    v_mfma_f32_16x16x32_bf16 v[40:43], v[176:179], v[76:79], v[40:43]
    v_mfma_f32_16x16x32_bf16 v[44:47], v[180:183], v[76:79], v[44:47]
    ds_read_b128 v[76:79], v25 offset:17184
    s_waitcnt lgkmcnt(5)
    v_mfma_f32_16x16x32_bf16 v[40:43], v[184:187], v[56:59], v[40:43]
    v_mfma_f32_16x16x32_bf16 v[44:47], v[188:191], v[56:59], v[44:47]
    ds_read_b128 v[56:59], v25 offset:17216
    s_waitcnt lgkmcnt(5)
    v_mfma_f32_16x16x32_bf16 v[40:43], v[192:195], v[60:63], v[40:43]
    v_mfma_f32_16x16x32_bf16 v[44:47], v[196:199], v[60:63], v[44:47]
    ds_read_b128 v[60:63], v25 offset:17248
    s_waitcnt lgkmcnt(5)
    v_mfma_f32_16x16x32_bf16 v[40:43], v[200:203], v[64:67], v[40:43]
    v_mfma_f32_16x16x32_bf16 v[44:47], v[204:207], v[64:67], v[44:47]
    ds_read_b128 v[64:67], v25 offset:17280
    s_waitcnt lgkmcnt(5)
    v_mfma_f32_16x16x32_bf16 v[40:43], v[208:211], v[68:71], v[40:43]
    v_mfma_f32_16x16x32_bf16 v[44:47], v[212:215], v[68:71], v[44:47]
    ds_read_b128 v[68:71], v25 offset:17312
    s_waitcnt lgkmcnt(5)
    v_mfma_f32_16x16x32_bf16 v[48:51], v[152:155], v[72:75], v[48:51]
    v_mfma_f32_16x16x32_bf16 v[52:55], v[156:159], v[72:75], v[52:55]
    ds_read_b128 v[72:75], v25 offset:17344
    s_waitcnt lgkmcnt(5)
    v_mfma_f32_16x16x32_bf16 v[48:51], v[160:163], v[76:79], v[48:51]
    v_mfma_f32_16x16x32_bf16 v[52:55], v[164:167], v[76:79], v[52:55]
    ds_read_b128 v[76:79], v25 offset:17376
    s_waitcnt lgkmcnt(5)
    v_mfma_f32_16x16x32_bf16 v[48:51], v[168:171], v[56:59], v[48:51]
    v_mfma_f32_16x16x32_bf16 v[52:55], v[172:175], v[56:59], v[52:55]
    v_cvt_pk_bf16_f32 v92, v40, v44
    v_cvt_pk_bf16_f32 v93, v41, v45
    v_cvt_pk_bf16_f32 v94, v42, v46
    v_cvt_pk_bf16_f32 v95, v43, v47
    buffer_store_dwordx4 v[92:95], v0, s[52:55], s90 offen sc1
    s_waitcnt lgkmcnt(4)
    v_mfma_f32_16x16x32_bf16 v[48:51], v[176:179], v[60:63], v[48:51]
    v_mfma_f32_16x16x32_bf16 v[52:55], v[180:183], v[60:63], v[52:55]
    s_waitcnt lgkmcnt(3)
    v_mfma_f32_16x16x32_bf16 v[48:51], v[184:187], v[64:67], v[48:51]
    v_mfma_f32_16x16x32_bf16 v[52:55], v[188:191], v[64:67], v[52:55]
    s_waitcnt lgkmcnt(2)
    v_mfma_f32_16x16x32_bf16 v[48:51], v[192:195], v[68:71], v[48:51]
    v_mfma_f32_16x16x32_bf16 v[52:55], v[196:199], v[68:71], v[52:55]
    s_waitcnt lgkmcnt(1)
    v_mfma_f32_16x16x32_bf16 v[48:51], v[200:203], v[72:75], v[48:51]
    v_mfma_f32_16x16x32_bf16 v[52:55], v[204:207], v[72:75], v[52:55]
    s_waitcnt lgkmcnt(0)
    v_mfma_f32_16x16x32_bf16 v[48:51], v[208:211], v[76:79], v[48:51]
    v_mfma_f32_16x16x32_bf16 v[52:55], v[212:215], v[76:79], v[52:55]
    s_nop 7
    v_cvt_pk_bf16_f32 v96, v48, v52
    v_cvt_pk_bf16_f32 v97, v49, v53
    v_cvt_pk_bf16_f32 v98, v50, v54
    v_cvt_pk_bf16_f32 v99, v51, v55
    s_mov_b32 exec_lo, 0x00ff00ff
    s_mov_b32 exec_hi, 0x00ff00ff
    buffer_store_dwordx4 v[96:99], v0, s[52:55], s91 offen sc1
    s_mov_b64 exec, 1
    v_mov_b32 v5, s30
    v_mov_b32 v6, 0
    s_lshr_b32 s63, s3, 1
    s_or_b32 s63, s63, s60
    s_cmp_lg_u32 s63, 0
    s_cbranch_scc1 L_noep
    buffer_store_dword v5, v6, s[56:59], 0 offen
L_noep:
L_end:
    s_endpgm
L_pmiss:
    s_add_u32 s83, s83, 1
    s_cmp_ge_u32 s83, 100000
    s_cbranch_scc1 L_ptimeout
    s_sleep 4
    buffer_load_dwordx4 v[40:43], v120, s[56:59], s100 offen sc1
    s_waitcnt vmcnt(0)
    s_branch L_pchk
L_ptimeout:
    s_mov_b64 exec, -1
    v_mov_b32 v5, 0
    v_mov_b32 v6, 3
    ds_or_b32 v5, v6 offset:256
    v_mov_b32 v40, 1032192
    v_mov_b32 v56, 1032192
    v_mov_b32 v41, 1032192
    v_mov_b32 v57, 1032192
    v_mov_b32 v42, 1032192
    v_mov_b32 v58, 1032192
    v_mov_b32 v43, 1032192
    v_mov_b32 v59, 1032192
    s_branch L_polled
L_setovf:
    s_and_b32 s76, vcc_lo, 0x11111111
    s_and_b32 s77, vcc_hi, 0x11111111
    s_mov_b64 exec, vcc
    v_mov_b32 v40, 1032192
    v_mov_b32 v41, 1032192
    v_mov_b32 v42, 1032192
    v_mov_b32 v43, 1032192
    s_mov_b64 exec, -1
    s_branch L_noovf
L_cont_p:
    s_lshr_b32 s12, s30, 12
    s_add_u32 s12, s12, 0
    s_lshl_b32 s12, s12, 20
    s_lshr_b32 s13, s30, 12
    s_add_u32 s13, s13, 1365
    s_lshl_b32 s13, s13, 20
    s_lshr_b32 s14, s30, 12
    s_add_u32 s14, s14, 2730
    s_lshl_b32 s14, s14, 20
    s_lshr_b32 s15, s30, 12
    s_add_u32 s15, s15, 963
    s_lshl_b32 s15, s15, 20
    v_and_b32 v4, 3, v0
    s_lshl_b32 s65, s84, 5
    s_add_u32 s65, s65, 4194304
    v_lshlrev_b32 v48, 3, v7
    v_lshlrev_b32 v49, 10, v7
    v_cmp_lt_u32 vcc, 23, v112
    s_nop 1
    v_cndmask_b32 v32, v32, v5, vcc
    v_cmp_lt_u32 s[68:69], 16, v112
    v_cmp_eq_u32 s[70:71], 3, v4
    s_andn2_b64 s[68:69], s[68:69], vcc
    s_and_b64 exec, s[68:69], s[70:71]
    s_cbranch_execz L_cp_54
    ds_read_b128 v[52:55], v48 offset:34944
    ds_read_b128 v[56:59], v48 offset:34960
    s_waitcnt lgkmcnt(0)
    v_mov_b32 v59, v35
    v_mov_b32 v35, 999424
    v_or_b32 v52, s4, v52
    v_or_b32 v53, s5, v53
    v_or_b32 v54, s6, v54
    v_or_b32 v55, s7, v55
    v_or_b32 v56, s12, v56
    v_or_b32 v57, s13, v57
    v_or_b32 v58, s14, v58
    v_or_b32 v59, s15, v59
    buffer_store_dwordx4 v[52:55], v49, s[56:59], s65 offen sc1
    buffer_store_dwordx4 v[56:59], v49, s[56:59], s65 offen offset:16 sc1
    s_nop 1
L_cp_54:
    s_mov_b64 exec, -1
    s_add_u32 s65, s65, 524288
    v_cmp_lt_u32 vcc, 23, v113
    s_nop 1
    v_cndmask_b32 v36, v36, v5, vcc
    v_cmp_lt_u32 s[68:69], 16, v113
    v_cmp_eq_u32 s[70:71], 3, v4
    s_andn2_b64 s[68:69], s[68:69], vcc
    s_and_b64 exec, s[68:69], s[70:71]
    s_cbranch_execz L_cp_55
    ds_read_b128 v[52:55], v48 offset:39040
    ds_read_b128 v[56:59], v48 offset:39056
    s_waitcnt lgkmcnt(0)
    v_mov_b32 v59, v39
    v_mov_b32 v39, 999424
    v_or_b32 v52, s4, v52
    v_or_b32 v53, s5, v53
    v_or_b32 v54, s6, v54
    v_or_b32 v55, s7, v55
    v_or_b32 v56, s12, v56
    v_or_b32 v57, s13, v57
    v_or_b32 v58, s14, v58
    v_or_b32 v59, s15, v59
    buffer_store_dwordx4 v[52:55], v49, s[56:59], s65 offen sc1
    buffer_store_dwordx4 v[56:59], v49, s[56:59], s65 offen offset:16 sc1
    s_nop 1
L_cp_55:
    s_mov_b64 exec, -1
    s_add_u32 s65, s65, 524288
    s_branch L_cont_pd
L_more:
    s_cmp_eq_u64 s[8:9], 0
    s_cbranch_scc1 L_rescan
    s_cmp_lg_u32 s10, 0
    s_cbranch_scc1 L_cont2
    s_mov_b32 s10, 1
    s_lshl_b32 s64, s2, 12
    s_add_u32 s64, s64, 4194304
    v_lshrrev_b32 v4, 6, v120
    v_lshlrev_b32 v4, 5, v4
    v_mov_b32 v40, 1032192
    v_mov_b32 v56, 1032192
    v_mov_b32 v41, 1032192
    v_mov_b32 v57, 1032192
    v_mov_b32 v42, 1032192
    v_mov_b32 v58, 1032192
    v_mov_b32 v43, 1032192
    v_mov_b32 v59, 1032192
    s_lshr_b32 s12, s30, 12
    s_add_u32 s12, s12, 0
    s_lshl_b32 s12, s12, 20
    s_lshr_b32 s13, s30, 12
    s_add_u32 s13, s13, 1365
    s_lshl_b32 s13, s13, 20
    s_lshr_b32 s14, s30, 12
    s_add_u32 s14, s14, 2730
    s_lshl_b32 s14, s14, 20
    s_lshr_b32 s15, s30, 12
    s_add_u32 s15, s15, 963
    s_lshl_b32 s15, s15, 20
    s_mov_b64 exec, s[8:9]
L_cpoll:
    buffer_load_dwordx4 v[40:43], v4, s[56:59], s64 offen sc1
    buffer_load_dwordx4 v[56:59], v4, s[56:59], s64 offen offset:16 sc1
    s_add_u32 s83, s83, 1
    s_waitcnt vmcnt(0)
    v_xor_b32 v40, s4, v40
    v_xor_b32 v56, s12, v56
    v_xor_b32 v41, s5, v41
    v_xor_b32 v57, s13, v57
    v_xor_b32 v42, s6, v42
    v_xor_b32 v58, s14, v58
    v_xor_b32 v43, s7, v43
    v_xor_b32 v59, s15, v59
    v_or3_b32 v5, v40, v41, v42
    v_or3_b32 v6, v56, v57, v58
    v_or3_b32 v5, v5, v43, v59
    v_or_b32 v5, v5, v6
    v_cmp_le_u32 vcc, s65, v5
    s_and_b64 exec, exec, vcc
    s_cbranch_execz L_cok
    s_cmp_lt_u32 s83, 100000
    s_cbranch_scc1 L_cpoll
    s_mov_b64 exec, -1
    v_mov_b32 v5, 0
    v_mov_b32 v6, 3
    ds_or_b32 v5, v6 offset:256
    v_mov_b32 v40, 1032192
    v_mov_b32 v56, 1032192
    v_mov_b32 v41, 1032192
    v_mov_b32 v57, 1032192
    v_mov_b32 v42, 1032192
    v_mov_b32 v58, 1032192
    v_mov_b32 v43, 1032192
    v_mov_b32 v59, 1032192
L_cok:
    s_mov_b64 exec, -1
    s_branch L_ins
L_cont2:
    v_mov_b32 v40, v56
    v_mov_b32 v41, v57
    v_mov_b32 v42, v58
    v_mov_b32 v43, v59
    s_mov_b64 s[8:9], 0
    s_branch L_ins
L_rescan:
    s_ff1_i32_b64 s63, s[76:77]
    s_lshr_b32 s64, s63, 2
    s_lshl_b32 s66, s60, 4
    s_add_u32 s64, s64, s66
    s_mul_i32 s64, s64, 5120
    s_lshl_b32 s66, s92, 10
    s_add_u32 s64, s64, s66
    buffer_load_dwordx4 v[56:59], v28, s[40:43], s64 offen
    buffer_load_dwordx4 v[40:43], v28, s[36:39], s64 offen
    s_add_u32 s92, s92, 1
    s_cmp_lt_u32 s92, 5
    s_cbranch_scc1 L_rs1
    s_mov_b32 s92, 0
    s_bitset0_b64 s[76:77], s63
L_rs1:
    s_waitcnt vmcnt(0)
    v_subrev_u32 v56, s96, v56
    v_min_u32 v56, 63, v56
    v_lshl_or_b32 v40, v56, 14, v40
    v_subrev_u32 v57, s96, v57
    v_min_u32 v57, 63, v57
    v_lshl_or_b32 v41, v57, 14, v41
    v_subrev_u32 v58, s96, v58
    v_min_u32 v58, 63, v58
    v_lshl_or_b32 v42, v58, 14, v42
    v_subrev_u32 v59, s96, v59
    v_min_u32 v59, 63, v59
    v_lshl_or_b32 v43, v59, 14, v43
    s_branch L_ins
L_big:
    s_cmp_gt_u32 s13, 104
    s_cbranch_scc1 L_slow
    s_lshl_b32 s14, s22, 8
    s_lshl_b32 s15, s23, 5
    s_sub_u32 s15, s15, s8
    s_lshl_b32 s15, s15, 3
    s_lshl_b32 s16, s24, 5
    s_sub_u32 s16, s16, s9
    s_lshl_b32 s16, s16, 3
    s_lshl_b32 s17, s25, 5
    s_sub_u32 s17, s17, s10
    s_lshl_b32 s17, s17, 3
    s_lshl_b32 s18, s26, 5
    s_sub_u32 s18, s18, s11
    s_lshl_b32 s18, s18, 3
    s_lshl_b32 s19, s27, 5
    s_sub_u32 s19, s19, s12
    s_lshl_b32 s19, s19, 3
    v_add_u32 v4, 0, v1
    v_mov_b32 v6, s14
    v_cmp_le_u32 vcc, s8, v4
    v_mov_b32 v7, s15
    s_nop 0
    v_cndmask_b32 v6, v6, v7, vcc
    v_cmp_le_u32 vcc, s9, v4
    v_mov_b32 v7, s16
    s_nop 0
    v_cndmask_b32 v6, v6, v7, vcc
    v_cmp_le_u32 vcc, s10, v4
    v_mov_b32 v7, s17
    s_nop 0
    v_cndmask_b32 v6, v6, v7, vcc
    v_cmp_le_u32 vcc, s11, v4
    v_mov_b32 v7, s18
    s_nop 0
    v_cndmask_b32 v6, v6, v7, vcc
    v_cmp_le_u32 vcc, s12, v4
    v_mov_b32 v7, s19
    s_nop 0
    v_cndmask_b32 v6, v6, v7, vcc
    v_lshl_add_u32 v6, v4, 3, v6
    v_mov_b32 v16, 2130706432
    v_mov_b32 v17, 2130706432
    v_cmp_gt_u32 vcc, s13, v4
    s_mov_b64 exec, vcc
    ds_read_b64 v[16:17], v6 offset:3584
    s_mov_b64 exec, -1
    v_lshrrev_b32 v7, 2, v4
    v_lshlrev_b32 v7, 5, v7
    v_and_b32 v5, 3, v4
    v_lshl_add_u32 v7, v5, 2, v7
    s_lshl_b32 s31, s60, 10
    v_add_u32 v7, s31, v7
    v_add_u32 v7, 34944, v7
    s_waitcnt lgkmcnt(0)
    ds_write2_b32 v7, v16, v17 offset0:0 offset1:4
    v_add_u32 v4, 64, v1
    v_mov_b32 v6, s14
    v_cmp_le_u32 vcc, s8, v4
    v_mov_b32 v7, s15
    s_nop 0
    v_cndmask_b32 v6, v6, v7, vcc
    v_cmp_le_u32 vcc, s9, v4
    v_mov_b32 v7, s16
    s_nop 0
    v_cndmask_b32 v6, v6, v7, vcc
    v_cmp_le_u32 vcc, s10, v4
    v_mov_b32 v7, s17
    s_nop 0
    v_cndmask_b32 v6, v6, v7, vcc
    v_cmp_le_u32 vcc, s11, v4
    v_mov_b32 v7, s18
    s_nop 0
    v_cndmask_b32 v6, v6, v7, vcc
    v_cmp_le_u32 vcc, s12, v4
    v_mov_b32 v7, s19
    s_nop 0
    v_cndmask_b32 v6, v6, v7, vcc
    v_lshl_add_u32 v6, v4, 3, v6
    v_mov_b32 v16, 2130706432
    v_mov_b32 v17, 2130706432
    v_cmp_gt_u32 vcc, s13, v4
    s_mov_b64 exec, vcc
    ds_read_b64 v[16:17], v6 offset:3584
    s_mov_b64 exec, -1
    v_lshrrev_b32 v7, 2, v4
    v_lshlrev_b32 v7, 5, v7
    v_and_b32 v5, 3, v4
    v_lshl_add_u32 v7, v5, 2, v7
    s_lshl_b32 s31, s60, 10
    v_add_u32 v7, s31, v7
    v_add_u32 v7, 34944, v7
    s_waitcnt lgkmcnt(0)
    ds_write2_b32 v7, v16, v17 offset0:0 offset1:4
    s_sub_u32 s31, s8, 1
    s_cmp_ge_u32 s31, 64
    s_cbranch_scc1 L_bm_56
    s_bitset1_b64 s[76:77], s31
    s_branch L_bm_57
L_bm_56:
    s_bitset1_b64 s[78:79], s31
L_bm_57:
    s_sub_u32 s31, s9, 1
    s_cmp_ge_u32 s31, 64
    s_cbranch_scc1 L_bm_58
    s_bitset1_b64 s[76:77], s31
    s_branch L_bm_59
L_bm_58:
    s_bitset1_b64 s[78:79], s31
L_bm_59:
    s_sub_u32 s31, s10, 1
    s_cmp_ge_u32 s31, 64
    s_cbranch_scc1 L_bm_60
    s_bitset1_b64 s[76:77], s31
    s_branch L_bm_61
L_bm_60:
    s_bitset1_b64 s[78:79], s31
L_bm_61:
    s_sub_u32 s31, s11, 1
    s_cmp_ge_u32 s31, 64
    s_cbranch_scc1 L_bm_62
    s_bitset1_b64 s[76:77], s31
    s_branch L_bm_63
L_bm_62:
    s_bitset1_b64 s[78:79], s31
L_bm_63:
    s_sub_u32 s31, s12, 1
    s_cmp_ge_u32 s31, 64
    s_cbranch_scc1 L_bm_64
    s_bitset1_b64 s[76:77], s31
    s_branch L_bm_65
L_bm_64:
    s_bitset1_b64 s[78:79], s31
L_bm_65:
    s_sub_u32 s31, s13, 1
    s_cmp_ge_u32 s31, 64
    s_cbranch_scc1 L_bm_66
    s_bitset1_b64 s[76:77], s31
    s_branch L_bm_67
L_bm_66:
    s_bitset1_b64 s[78:79], s31
L_bm_67:
    s_branch L_listdone
L_w2miss:
    s_add_u32 s66, s66, 1
    s_cmp_ge_u32 s66, 100000
    s_cbranch_scc1 L_w2self
    s_sleep 2
    buffer_load_dwordx4 v[124:127], v28, s[56:59], s100 offen sc1
    s_branch L_chk2
L_w2self:
    s_or_b32 s3, s3, 2
    s_lshl_b32 s67, s2, 19
    s_add_u32 s67, s67, 16777216
    s_lshl_b32 s87, s60, 4
L_selfw2:
    v_lshrrev_b32 v6, 5, v1
    v_bfe_u32 v7, v1, 4, 1
    v_lshl_add_u32 v5, v7, 4, v6
    s_and_b32 s64, s87, 7
    s_lshl_b32 s64, s64, 1
    s_and_b32 s63, s87, 8
    s_lshl_b32 s63, s63, 2
    s_add_u32 s64, s64, s63
    v_add_u32 v5, s64, v5
    v_lshrrev_b32 v6, 2, v5
    v_and_b32 v5, 3, v5
    v_lshlrev_b32 v6, 14, v6
    v_lshl_add_u32 v6, v5, 11, v6
    v_and_b32 v5, 15, v1
    v_lshl_add_u32 v6, v5, 2, v6
    s_lshr_b32 s63, s87, 4
    s_lshl_b32 s63, s63, 6
    s_add_u32 s64, s63, 8192
    buffer_load_dword v80, v6, s[48:51], s63 offen offset:0
    buffer_load_dword v81, v6, s[48:51], s63 offen offset:512
    buffer_load_dword v82, v6, s[48:51], s63 offen offset:1024
    buffer_load_dword v83, v6, s[48:51], s63 offen offset:1536
    buffer_load_dword v84, v6, s[48:51], s64 offen offset:0
    buffer_load_dword v85, v6, s[48:51], s64 offen offset:512
    buffer_load_dword v86, v6, s[48:51], s64 offen offset:1024
    buffer_load_dword v87, v6, s[48:51], s64 offen offset:1536
    s_lshl_b32 s63, s87, 11
    s_add_u32 s63, s63, s67
    s_mov_b32 s85, 0x05040100
    s_mov_b32 s99, 0x07060302
    s_waitcnt vmcnt(0)
    v_perm_b32 v88, v81, v80, s85
    v_perm_b32 v92, v81, v80, s99
    v_perm_b32 v89, v83, v82, s85
    v_perm_b32 v93, v83, v82, s99
    v_perm_b32 v90, v85, v84, s85
    v_perm_b32 v94, v85, v84, s99
    v_perm_b32 v91, v87, v86, s85
    v_perm_b32 v95, v87, v86, s99
    buffer_store_dwordx4 v[88:91], v28, s[56:59], s63 offen sc1
    buffer_store_dwordx4 v[92:95], v28, s[56:59], s63 offen offset:1024 sc1
    s_nop 1
    s_add_u32 s87, s87, 1
    s_and_b32 s63, s87, 15
    s_cmp_lg_u32 s63, 0
    s_cbranch_scc1 L_selfw2
    s_lshl_b32 s63, s60, 15
    s_add_u32 s67, s67, s63
    s_mov_b32 s87, 0
    v_lshrrev_b32 v6, 5, v1
    v_bfe_u32 v7, v1, 4, 1
    v_lshl_add_u32 v5, v7, 4, v6
    v_and_b32 v7, 15, v1
    v_lshlrev_b32 v7, 1, v7
    v_lshl_add_u32 v6, v5, 13, v7
L_selfw1:
    s_lshr_b32 s63, s87, 2
    s_lshl_b32 s63, s63, 14
    s_and_b32 s64, s87, 3
    s_lshl_b32 s64, s64, 5
    s_add_u32 s63, s63, s64
    s_lshl_b32 s64, s60, 7
    s_add_u32 s63, s63, s64
    s_add_u32 s64, s63, 4096
    buffer_load_ushort v80, v6, s[44:47], s63 offen offset:0
    buffer_load_ushort v81, v6, s[44:47], s63 offen offset:1024
    buffer_load_ushort v82, v6, s[44:47], s63 offen offset:2048
    buffer_load_ushort v83, v6, s[44:47], s63 offen offset:3072
    buffer_load_ushort v84, v6, s[44:47], s64 offen offset:0
    buffer_load_ushort v85, v6, s[44:47], s64 offen offset:1024
    buffer_load_ushort v86, v6, s[44:47], s64 offen offset:2048
    buffer_load_ushort v87, v6, s[44:47], s64 offen offset:3072
    s_lshl_b32 s63, s87, 10
    s_add_u32 s63, s63, s67
    s_add_u32 s63, s63, 262144
    s_waitcnt vmcnt(0)
    v_lshl_or_b32 v88, v81, 16, v80
    v_lshl_or_b32 v89, v83, 16, v82
    v_lshl_or_b32 v90, v85, 16, v84
    v_lshl_or_b32 v91, v87, 16, v86
    buffer_store_dwordx4 v[88:91], v28, s[56:59], s63 offen sc1
    s_add_u32 s87, s87, 1
    s_cmp_lt_u32 s87, 32
    s_cbranch_scc1 L_selfw1
    s_waitcnt vmcnt(0)
    s_branch L_w2ok
L_slow:
    s_waitcnt vmcnt(0)
    ds_read_b64_tr_b16 v[176:177], v124 offset:0
    ds_read_b64_tr_b16 v[178:179], v124 offset:512
    ds_read_b64_tr_b16 v[180:181], v125 offset:0
    ds_read_b64_tr_b16 v[182:183], v125 offset:512
    ds_read_b64_tr_b16 v[184:185], v126 offset:0
    ds_read_b64_tr_b16 v[186:187], v126 offset:512
    ds_read_b64_tr_b16 v[188:189], v127 offset:0
    ds_read_b64_tr_b16 v[190:191], v127 offset:512
    ds_read_b64_tr_b16 v[192:193], v124 offset:4096
    ds_read_b64_tr_b16 v[194:195], v124 offset:4608
    ds_read_b64_tr_b16 v[196:197], v125 offset:4096
    ds_read_b64_tr_b16 v[198:199], v125 offset:4608
    ds_read_b64_tr_b16 v[200:201], v126 offset:4096
    ds_read_b64_tr_b16 v[202:203], v126 offset:4608
    ds_read_b64_tr_b16 v[204:205], v127 offset:4096
    ds_read_b64_tr_b16 v[206:207], v127 offset:4608
    ds_read_b64_tr_b16 v[208:209], v124 offset:8192
    ds_read_b64_tr_b16 v[210:211], v124 offset:8704
    ds_read_b64_tr_b16 v[212:213], v125 offset:8192
    ds_read_b64_tr_b16 v[214:215], v125 offset:8704
    ds_read_b64_tr_b16 v[216:217], v126 offset:8192
    ds_read_b64_tr_b16 v[218:219], v126 offset:8704
    ds_read_b64_tr_b16 v[220:221], v127 offset:8192
    ds_read_b64_tr_b16 v[222:223], v127 offset:8704
    v_mov_b32 v4, 2130706432
    v_cmp_gt_u32 vcc, 32, v1
    s_mov_b32 s81, 0
    v_lshlrev_b32 v59, 2, v1
    v_cndmask_b32 v58, v4, v20, vcc
    s_add_u32 s8, s22, s96
    s_add_u32 s9, s23, s96
    s_add_u32 s10, s24, s96
    s_add_u32 s11, s25, s96
    s_add_u32 s12, s26, s96
    s_add_u32 s13, s27, s96
    s_cmp_lt_u32 s60, 4
    s_cselect_b32 s12, s12, -1
    s_cselect_b32 s13, s13, -1
    v_mov_b32 v32, 0
    v_mov_b32 v33, 0
    v_mov_b32 v34, 0
    v_mov_b32 v35, 0
    v_mov_b32 v36, 0
    v_mov_b32 v37, 0
    v_mov_b32 v38, 0
    v_mov_b32 v39, 0
    v_mov_b32 v40, 0
    v_mov_b32 v41, 0
    v_mov_b32 v42, 0
    v_mov_b32 v43, 0
    v_mov_b32 v44, 0
    v_mov_b32 v45, 0
    v_mov_b32 v46, 0
    v_mov_b32 v47, 0
    v_mov_b32 v48, 0
    v_mov_b32 v49, 0
    v_mov_b32 v50, 0
    v_mov_b32 v51, 0
    v_mov_b32 v52, 0
    v_mov_b32 v53, 0
    v_mov_b32 v54, 0
    v_mov_b32 v55, 0
L_sloop:
    buffer_load_dword v56, v59, s[40:43], s81 offen
    buffer_load_dword v57, v59, s[36:39], s81 offen
    s_waitcnt vmcnt(0)
    v_lshlrev_b32 v57, 9, v57
    v_cmp_eq_u32 s[90:91], s8, v56
L_s_68:
    s_nop 3
    s_cmp_eq_u64 s[90:91], 0
    s_cbranch_scc1 L_s_69
    s_ff1_i32_b64 s64, s[90:91]
    s_bitset0_b64 s[90:91], s64
    v_readlane_b32 s65, v57, s64
    s_nop 4
    buffer_load_dwordx4 v[60:63], v58, s[32:35], s65 offen
    s_waitcnt vmcnt(0)
    v_mfma_f32_16x16x32_bf16 v[32:35], v[8:11], v[60:63], v[32:35]
    s_nop 7
    s_branch L_s_68
L_s_69:
    v_cmp_eq_u32 s[90:91], s9, v56
L_s_70:
    s_nop 3
    s_cmp_eq_u64 s[90:91], 0
    s_cbranch_scc1 L_s_71
    s_ff1_i32_b64 s64, s[90:91]
    s_bitset0_b64 s[90:91], s64
    v_readlane_b32 s65, v57, s64
    s_nop 4
    buffer_load_dwordx4 v[60:63], v58, s[32:35], s65 offen
    s_waitcnt vmcnt(0)
    v_mfma_f32_16x16x32_bf16 v[36:39], v[8:11], v[60:63], v[36:39]
    s_nop 7
    s_branch L_s_70
L_s_71:
    v_cmp_eq_u32 s[90:91], s10, v56
L_s_72:
    s_nop 3
    s_cmp_eq_u64 s[90:91], 0
    s_cbranch_scc1 L_s_73
    s_ff1_i32_b64 s64, s[90:91]
    s_bitset0_b64 s[90:91], s64
    v_readlane_b32 s65, v57, s64
    s_nop 4
    buffer_load_dwordx4 v[60:63], v58, s[32:35], s65 offen
    s_waitcnt vmcnt(0)
    v_mfma_f32_16x16x32_bf16 v[40:43], v[8:11], v[60:63], v[40:43]
    s_nop 7
    s_branch L_s_72
L_s_73:
    v_cmp_eq_u32 s[90:91], s11, v56
L_s_74:
    s_nop 3
    s_cmp_eq_u64 s[90:91], 0
    s_cbranch_scc1 L_s_75
    s_ff1_i32_b64 s64, s[90:91]
    s_bitset0_b64 s[90:91], s64
    v_readlane_b32 s65, v57, s64
    s_nop 4
    buffer_load_dwordx4 v[60:63], v58, s[32:35], s65 offen
    s_waitcnt vmcnt(0)
    v_mfma_f32_16x16x32_bf16 v[44:47], v[8:11], v[60:63], v[44:47]
    s_nop 7
    s_branch L_s_74
L_s_75:
    v_cmp_eq_u32 s[90:91], s12, v56
L_s_76:
    s_nop 3
    s_cmp_eq_u64 s[90:91], 0
    s_cbranch_scc1 L_s_77
    s_ff1_i32_b64 s64, s[90:91]
    s_bitset0_b64 s[90:91], s64
    v_readlane_b32 s65, v57, s64
    s_nop 4
    buffer_load_dwordx4 v[60:63], v58, s[32:35], s65 offen
    s_waitcnt vmcnt(0)
    v_mfma_f32_16x16x32_bf16 v[48:51], v[8:11], v[60:63], v[48:51]
    s_nop 7
    s_branch L_s_76
L_s_77:
    v_cmp_eq_u32 s[90:91], s13, v56
L_s_78:
    s_nop 3
    s_cmp_eq_u64 s[90:91], 0
    s_cbranch_scc1 L_s_79
    s_ff1_i32_b64 s64, s[90:91]
    s_bitset0_b64 s[90:91], s64
    v_readlane_b32 s65, v57, s64
    s_nop 4
    buffer_load_dwordx4 v[60:63], v58, s[32:35], s65 offen
    s_waitcnt vmcnt(0)
    v_mfma_f32_16x16x32_bf16 v[52:55], v[8:11], v[60:63], v[52:55]
    s_nop 7
    s_branch L_s_78
L_s_79:
    s_add_u32 s81, s81, 256
    s_cmp_lt_u32 s81, 640000
    s_cbranch_scc1 L_sloop
    s_nop 7
    v_mov_b32 v12, v32
    v_mov_b32 v13, v33
    v_mov_b32 v14, v34
    v_mov_b32 v15, v35
    s_call_b64 s[88:89], L_fin
    v_mov_b32 v12, v36
    v_mov_b32 v13, v37
    v_mov_b32 v14, v38
    v_mov_b32 v15, v39
    s_call_b64 s[88:89], L_fin
    v_mov_b32 v12, v40
    v_mov_b32 v13, v41
    v_mov_b32 v14, v42
    v_mov_b32 v15, v43
    s_call_b64 s[88:89], L_fin
    v_mov_b32 v12, v44
    v_mov_b32 v13, v45
    v_mov_b32 v14, v46
    v_mov_b32 v15, v47
    s_call_b64 s[88:89], L_fin
    v_mov_b32 v12, v48
    v_mov_b32 v13, v49
    v_mov_b32 v14, v50
    v_mov_b32 v15, v51
    s_call_b64 s[88:89], L_fin
    v_mov_b32 v12, v52
    v_mov_b32 v13, v53
    v_mov_b32 v14, v54
    v_mov_b32 v15, v55
    s_call_b64 s[88:89], L_fin
    s_endpgm
.section .rodata,"a"
.p2align 6
.amdhsa_kernel gather_scatter__isomorphism_gin_2__graph_kernel
  .amdhsa_next_free_vgpr 256
  .amdhsa_next_free_sgpr 102
  .amdhsa_accum_offset 256
  .amdhsa_group_segment_fixed_size 0
  .amdhsa_kernarg_size 88
  .amdhsa_user_sgpr_count 2
  .amdhsa_user_sgpr_kernarg_segment_ptr 1
  .amdhsa_system_sgpr_workgroup_id_x 1
.end_amdhsa_kernel
```
